```python
import torch

def _softmax(x, axis=-1):
    return torch.softmax(x, dim=axis)
def _gelu(x):
    return torch.nn.functional.gelu(x, approximate="tanh")
def _silu(x):
    return torch.nn.functional.silu(x)
def _sigmoid(x):
    return torch.sigmoid(x)
def _layernorm(x, axis=-1, eps=1e-5):
    m = x.mean(dim=axis, keepdim=True)
    v = x.var(dim=axis, keepdim=True, unbiased=False)
    return (x - m) / torch.sqrt(v + eps)
def _scatter_add(tgt, idx, src, axis=0):
    return tgt.clone().index_add_(axis, idx, src)
def _segment_sum(src, seg, n):
    out = torch.zeros((n,) + src.shape[1:], dtype=src.dtype)
    return out.index_add_(0, seg, src)
def _pad(x, pw):
    flat = tuple(v for pair in reversed(pw) for v in pair)
    return torch.nn.functional.pad(x, flat)

kernel_name = 'recurrent_scan__ssm_conv_s4d__dense_activation_gelu__prompt'

def setup_inputs():

    _w = (lambda a: (lambda t: t.to(torch.bfloat16) if t.is_floating_point() else t)(torch.as_tensor(a)))
    def _A_setup():
        Bsz, L, D, N = 1, 2048, 512, 128
        return {
            "u": _w((lambda *s: torch.randn(*s, dtype=torch.bfloat16) * 0.05)(Bsz, L, D)),
            "log_A_real": _w((lambda *s: torch.randn(*s, dtype=torch.bfloat16) * 6.4)(D, N) * 0.5),
            "A_imag": _w((lambda *s: torch.randn(*s, dtype=torch.bfloat16) * 0.2)(D, N) * 3.14),
            "C_real": _w((lambda *s: torch.randn(*s, dtype=torch.bfloat16) * 0.4)(D, N) / N ** 0.5),
            "C_imag": _w((lambda *s: torch.randn(*s, dtype=torch.bfloat16) * 0.4)(D, N) / N ** 0.5),
            "log_dt": _w((lambda *s: torch.randn(*s, dtype=torch.bfloat16) * 0.2)(D) * 0.5 - 4.0),
            "D_skip": _w((lambda *s: torch.randn(*s, dtype=torch.bfloat16) * 0.2)(D)),
        }
    _A_in = _A_setup()

    def _B_setup():
        B, S, D, F = 1, 2048, 512, 1792
        return {
            "x": _w((lambda *s: torch.randn(*s, dtype=torch.bfloat16) * 0.05)(B, S, D)),
            "w1": _w((lambda *s: torch.randn(*s, dtype=torch.bfloat16) * 0.8)(D, F) * (D ** -0.5)),
            "b1": _w((lambda *s: torch.randn(*s, dtype=torch.bfloat16) * 0.1)(F) * 0.01),
            "w2": _w((lambda *s: torch.randn(*s, dtype=torch.bfloat16) * 0.1)(F, D) * (F ** -0.5)),
            "b2": _w((lambda *s: torch.randn(*s, dtype=torch.bfloat16) * 0.1)(D) * 0.01),
        }
    _B_in = _B_setup()

    return {
        "A_u": _A_in["u"],
        "A_log_A_real": _A_in["log_A_real"],
        "A_A_imag": _A_in["A_imag"],
        "A_C_real": _A_in["C_real"],
        "A_C_imag": _A_in["C_imag"],
        "A_log_dt": _A_in["log_dt"],
        "A_D_skip": _A_in["D_skip"],
        "B_x": _B_in["x"],
        "B_w1": _B_in["w1"],
        "B_b1": _B_in["b1"],
        "B_w2": _B_in["w2"],
        "B_b2": _B_in["b2"],
    }

def reference(A_u, A_log_A_real, A_A_imag, A_C_real, A_C_imag, A_log_dt, A_D_skip, B_x, B_w1, B_b1, B_w2, B_b2):
    def _A_ref(u, log_A_real, A_imag, C_real, C_imag, log_dt, D_skip):
        L = u.shape[1]
        dt = torch.exp(log_dt)
        A = -torch.exp(log_A_real) + 1j * A_imag
        C = (C_real + 1j * C_imag) * dt[:, None]
        pos = (lambda x, dt: x.to(dt))(torch.arange(L), log_dt.dtype)
        P = torch.exp((A * dt[:, None])[:, :, None] * pos[None, None, :])
        K = 2.0 * torch.einsum("dn,dnl->dl", C, P).real
        L2 = 2 * L
        u_t = (lambda x, *d: x.permute(*d))(u, 0, 2, 1)
        Kf = (lambda x, *a, **k: torch.fft.rfft(x.float(), *a, **k))(K, L2)
        Uf = (lambda x, *a, **k: torch.fft.rfft(x.float(), *a, **k))(u_t, L2)
        y = (lambda x, *a, **k: torch.fft.irfft(x, *a, **k).to(torch.bfloat16))(Uf * Kf[None, :, :], L2)[:, :, :L]
        y = (lambda x, *d: x.permute(*d))(y, 0, 2, 1)
        return y + u * D_skip[None, None, :]

    def _B_ref(x, w1, b1, w2, b2):
        h = torch.einsum("bsd,df->bsf", x, w1) + b1
        h = _gelu(h)
        return torch.einsum("bsf,fd->bsd", h, w2) + b2

    x = A_u
    xn = _layernorm(x, axis=-1)
    s = _A_ref(xn, A_log_A_real, A_A_imag, A_C_real, A_C_imag, A_log_dt, A_D_skip)
    g = _silu(_B_ref(xn, B_w1, B_b1, B_w2, B_b2))
    return x + s * g
```

```asm
; @launch grid=(512,1,1) block=(256,1,1) lds=81920
.amdgcn_target "amdgcn-amd-amdhsa--gfx950"
.text
.globl recurrent_scan__ssm_conv_s4d__dense_activation_gelu__prompt_kernel
.p2align 8
.type recurrent_scan__ssm_conv_s4d__dense_activation_gelu__prompt_kernel,@function
recurrent_scan__ssm_conv_s4d__dense_activation_gelu__prompt_kernel:
    s_cmp_ge_u32 s2, 512
    s_cbranch_scc1 F_END
    s_load_dwordx16 s[4:19], s[0:1], 0
    s_load_dwordx8 s[20:27], s[0:1], 64
    s_load_dwordx4 s[28:31], s[0:1], 96
    s_load_dwordx2 s[32:33], s[0:1], 112
    v_and_b32 v1, 63, v0
    v_readfirstlane_b32 s60, v0
    v_lshlrev_b32 v2, 4, v1
    s_lshr_b32 s60, s60, 6
    s_waitcnt lgkmcnt(0)
    s_add_u32 s36, s32, 0xf80000
    s_addc_u32 s37, s33, 0
    s_load_dword s35, s[36:37], 5120
    s_cmp_ge_u32 s2, 256
    s_cbranch_scc1 F_C
    s_setprio 2
    s_and_b32 s61, s2, 7
    s_lshr_b32 s62, s2, 3
    s_lshr_b32 s63, s61, 1
    s_lshl_b32 s63, s63, 2
    s_lshr_b32 s67, s62, 3
    s_add_u32 s63, s63, s67
    s_and_b32 s64, s61, 1
    s_lshl_b32 s64, s64, 3
    s_and_b32 s66, s62, 7
    s_add_u32 s64, s64, s66
    s_lshl_b32 s65, s61, 2
    s_add_u32 s65, s65, s67
    s_mov_b32 s36, s4
    s_mov_b32 s37, s5
    s_mov_b32 s38, 0x200000
    s_mov_b32 s39, 0x00020000
    s_lshl_b32 s67, s2, 13
    s_lshl_b32 s68, s60, 11
    s_add_u32 s67, s67, s68
    buffer_load_dwordx4 v[64:67], v2, s[36:39], s67 offen
    buffer_load_dwordx4 v[68:71], v2, s[36:39], s67 offen offset:1024
    s_mov_b32 s40, s20
    s_mov_b32 s41, s21
    s_mov_b32 s42, 0x1c0000
    s_mov_b32 s43, 0x00020000
    s_mov_b32 s44, s32
    s_mov_b32 s45, s33
    s_mov_b32 s46, 0x200000
    s_mov_b32 s47, 0x00020000
    s_add_u32 s48, s32, 0x200000
    s_addc_u32 s49, s33, 0
    s_mov_b32 s50, 0x200000
    s_mov_b32 s51, 0x00020000
    s_add_u32 s52, s32, 0xf80000
    s_addc_u32 s53, s33, 0
    s_mov_b32 s54, 0x14000
    s_mov_b32 s55, 0x00020000
    s_mov_b32 s56, s26
    s_mov_b32 s57, s27
    s_mov_b32 s58, 0x400
    s_mov_b32 s59, 0x00020000
    s_mul_i32 s70, s60, 224
    s_mov_b32 s72, 4682
    v_add_u32 v60, s70, v1
    v_mul_lo_u32 v230, v60, s72
    v_lshrrev_b32 v230, 16, v230
    v_mul_u32_u24 v231, 14, v230
    v_sub_u32 v231, v60, v231
    v_mul_u32_u24 v230, 3584, v230
    v_lshl_add_u32 v60, v231, 4, v230
    v_add_u32 v61, s70, v1
    v_add_u32 v61, 64, v61
    v_mul_lo_u32 v230, v61, s72
    v_lshrrev_b32 v230, 16, v230
    v_mul_u32_u24 v231, 14, v230
    v_sub_u32 v231, v61, v231
    v_mul_u32_u24 v230, 3584, v230
    v_lshl_add_u32 v61, v231, 4, v230
    v_add_u32 v62, s70, v1
    v_add_u32 v62, 128, v62
    v_mul_lo_u32 v230, v62, s72
    v_lshrrev_b32 v230, 16, v230
    v_mul_u32_u24 v231, 14, v230
    v_sub_u32 v231, v62, v231
    v_mul_u32_u24 v230, 3584, v230
    v_lshl_add_u32 v62, v231, 4, v230
    v_add_u32 v63, s70, v1
    v_add_u32 v63, 192, v63
    v_mul_lo_u32 v230, v63, s72
    v_lshrrev_b32 v230, 16, v230
    v_mul_u32_u24 v231, 14, v230
    v_sub_u32 v231, v63, v231
    v_mul_u32_u24 v230, 3584, v230
    v_lshl_add_u32 v63, v231, 4, v230
    s_mul_i32 s61, s64, 224
    s_mul_i32 s62, s60, 3584
    s_mov_b32 s72, 0xffff0000
    s_add_u32 s68, s61, 0
    s_add_u32 s70, s62, 0
    s_mov_b32 m0, s70
    s_nop 0
    buffer_load_dwordx4 v60, s[40:43], s68 offen lds
    s_add_u32 s70, s62, 1024
    s_mov_b32 m0, s70
    s_nop 0
    buffer_load_dwordx4 v61, s[40:43], s68 offen lds
    s_add_u32 s70, s62, 2048
    s_mov_b32 m0, s70
    s_nop 0
    buffer_load_dwordx4 v62, s[40:43], s68 offen lds
    s_add_u32 s70, s62, 3072
    s_mov_b32 m0, s70
    s_mov_b32 exec_hi, 0
    buffer_load_dwordx4 v63, s[40:43], s68 offen lds
    s_mov_b64 exec, -1
    s_add_u32 s68, s61, 229376
    s_add_u32 s70, s62, 14336
    s_mov_b32 m0, s70
    s_nop 0
    buffer_load_dwordx4 v60, s[40:43], s68 offen lds
    s_add_u32 s70, s62, 15360
    s_mov_b32 m0, s70
    s_nop 0
    buffer_load_dwordx4 v61, s[40:43], s68 offen lds
    s_add_u32 s70, s62, 16384
    s_mov_b32 m0, s70
    s_nop 0
    buffer_load_dwordx4 v62, s[40:43], s68 offen lds
    s_add_u32 s70, s62, 17408
    s_mov_b32 m0, s70
    s_mov_b32 exec_hi, 0
    buffer_load_dwordx4 v63, s[40:43], s68 offen lds
    s_mov_b64 exec, -1
    s_mov_b32 s36, s22
    s_mov_b32 s37, s23
    s_mov_b32 s38, 0xe00
    s_mov_b32 s39, 0x00020000
    v_lshrrev_b32 v235, 4, v1
    v_lshlrev_b32 v235, 3, v235
    buffer_load_dwordx2 v[216:217], v235, s[36:39], s61 offen offset:0
    buffer_load_dwordx2 v[218:219], v235, s[36:39], s61 offen offset:32
    buffer_load_dwordx2 v[220:221], v235, s[36:39], s61 offen offset:64
    buffer_load_dwordx2 v[222:223], v235, s[36:39], s61 offen offset:96
    buffer_load_dwordx2 v[224:225], v235, s[36:39], s61 offen offset:128
    buffer_load_dwordx2 v[226:227], v235, s[36:39], s61 offen offset:160
    buffer_load_dwordx2 v[228:229], v235, s[36:39], s61 offen offset:192
    s_mov_b32 s73, 0x3b000000
    s_waitcnt vmcnt(15)
    v_lshlrev_b32 v72, 16, v64
    v_and_b32 v73, s72, v64
    v_lshlrev_b32 v74, 16, v65
    v_and_b32 v75, s72, v65
    v_lshlrev_b32 v76, 16, v66
    v_and_b32 v77, s72, v66
    v_lshlrev_b32 v78, 16, v67
    v_and_b32 v79, s72, v67
    v_lshlrev_b32 v80, 16, v68
    v_and_b32 v81, s72, v68
    v_lshlrev_b32 v82, 16, v69
    v_and_b32 v83, s72, v69
    v_lshlrev_b32 v84, 16, v70
    v_and_b32 v85, s72, v70
    v_lshlrev_b32 v86, 16, v71
    v_and_b32 v87, s72, v71
    v_pk_add_f32 v[88:89], v[72:73], v[74:75]
    v_pk_add_f32 v[90:91], v[76:77], v[78:79]
    v_pk_add_f32 v[92:93], v[80:81], v[82:83]
    v_pk_add_f32 v[94:95], v[84:85], v[86:87]
    v_pk_add_f32 v[88:89], v[88:89], v[90:91]
    v_pk_add_f32 v[92:93], v[92:93], v[94:95]
    v_add_f32 v88, v88, v89
    v_add_f32 v92, v92, v93
    s_nop 0
    v_add_f32_dpp v88, v88, v88 quad_perm:[1,0,3,2] row_mask:0xf bank_mask:0xf
    v_add_f32_dpp v92, v92, v92 quad_perm:[1,0,3,2] row_mask:0xf bank_mask:0xf
    s_nop 0
    v_add_f32_dpp v88, v88, v88 quad_perm:[2,3,0,1] row_mask:0xf bank_mask:0xf
    v_add_f32_dpp v92, v92, v92 quad_perm:[2,3,0,1] row_mask:0xf bank_mask:0xf
    s_nop 0
    v_add_f32_dpp v88, v88, v88 row_half_mirror row_mask:0xf bank_mask:0xf
    v_add_f32_dpp v92, v92, v92 row_half_mirror row_mask:0xf bank_mask:0xf
    s_nop 0
    v_add_f32_dpp v88, v88, v88 row_mirror row_mask:0xf bank_mask:0xf
    v_add_f32_dpp v92, v92, v92 row_mirror row_mask:0xf bank_mask:0xf
    s_nop 0
    v_add_f32_dpp v88, v88, v88 row_bcast:15 row_mask:0xa bank_mask:0xf
    v_add_f32_dpp v92, v92, v92 row_bcast:15 row_mask:0xa bank_mask:0xf
    s_nop 0
    v_add_f32_dpp v88, v88, v88 row_bcast:31 row_mask:0xc bank_mask:0xf
    v_add_f32_dpp v92, v92, v92 row_bcast:31 row_mask:0xc bank_mask:0xf
    s_nop 0
    v_readlane_b32 s70, v88, 63
    v_readlane_b32 s71, v92, 63
    v_mov_b32 v90, s73
    s_nop 0
    v_mul_f32 v89, s70, v90
    v_mul_f32 v93, s71, v90
    v_mov_b32 v88, v89
    v_mov_b32 v92, v93
    v_pk_add_f32 v[96:97], v[72:73], v[88:89] neg_lo:[0,1] neg_hi:[0,1]
    v_pk_add_f32 v[98:99], v[74:75], v[88:89] neg_lo:[0,1] neg_hi:[0,1]
    v_pk_add_f32 v[100:101], v[76:77], v[88:89] neg_lo:[0,1] neg_hi:[0,1]
    v_pk_add_f32 v[102:103], v[78:79], v[88:89] neg_lo:[0,1] neg_hi:[0,1]
    v_pk_add_f32 v[104:105], v[80:81], v[92:93] neg_lo:[0,1] neg_hi:[0,1]
    v_pk_add_f32 v[106:107], v[82:83], v[92:93] neg_lo:[0,1] neg_hi:[0,1]
    v_pk_add_f32 v[108:109], v[84:85], v[92:93] neg_lo:[0,1] neg_hi:[0,1]
    v_pk_add_f32 v[110:111], v[86:87], v[92:93] neg_lo:[0,1] neg_hi:[0,1]
    v_pk_mul_f32 v[112:113], v[96:97], v[96:97]
    v_pk_mul_f32 v[114:115], v[104:105], v[104:105]
    v_pk_fma_f32 v[112:113], v[98:99], v[98:99], v[112:113]
    v_pk_fma_f32 v[114:115], v[106:107], v[106:107], v[114:115]
    v_pk_fma_f32 v[112:113], v[100:101], v[100:101], v[112:113]
    v_pk_fma_f32 v[114:115], v[108:109], v[108:109], v[114:115]
    v_pk_fma_f32 v[112:113], v[102:103], v[102:103], v[112:113]
    v_pk_fma_f32 v[114:115], v[110:111], v[110:111], v[114:115]
    v_add_f32 v112, v112, v113
    v_add_f32 v114, v114, v115
    s_nop 0
    v_add_f32_dpp v112, v112, v112 quad_perm:[1,0,3,2] row_mask:0xf bank_mask:0xf
    v_add_f32_dpp v114, v114, v114 quad_perm:[1,0,3,2] row_mask:0xf bank_mask:0xf
    s_nop 0
    v_add_f32_dpp v112, v112, v112 quad_perm:[2,3,0,1] row_mask:0xf bank_mask:0xf
    v_add_f32_dpp v114, v114, v114 quad_perm:[2,3,0,1] row_mask:0xf bank_mask:0xf
    s_nop 0
    v_add_f32_dpp v112, v112, v112 row_half_mirror row_mask:0xf bank_mask:0xf
    v_add_f32_dpp v114, v114, v114 row_half_mirror row_mask:0xf bank_mask:0xf
    s_nop 0
    v_add_f32_dpp v112, v112, v112 row_mirror row_mask:0xf bank_mask:0xf
    v_add_f32_dpp v114, v114, v114 row_mirror row_mask:0xf bank_mask:0xf
    s_nop 0
    v_add_f32_dpp v112, v112, v112 row_bcast:15 row_mask:0xa bank_mask:0xf
    v_add_f32_dpp v114, v114, v114 row_bcast:15 row_mask:0xa bank_mask:0xf
    s_nop 0
    v_add_f32_dpp v112, v112, v112 row_bcast:31 row_mask:0xc bank_mask:0xf
    v_add_f32_dpp v114, v114, v114 row_bcast:31 row_mask:0xc bank_mask:0xf
    s_nop 0
    v_readlane_b32 s70, v112, 63
    v_readlane_b32 s71, v114, 63
    s_mov_b32 s73, 0x3727c5ac
    v_cvt_pk_bf16_f32 v116, v89, v93
    v_mul_f32 v112, s70, v90
    v_mul_f32 v113, s71, v90
    v_lshlrev_b32 v89, 16, v116
    v_and_b32 v93, s72, v116
    v_lshlrev_b32 v88, 16, v116
    v_and_b32 v92, s72, v116
    v_cvt_pk_bf16_f32 v116, v112, v113
    v_lshlrev_b32 v112, 16, v116
    v_and_b32 v113, s72, v116
    v_add_f32 v112, s73, v112
    v_add_f32 v113, s73, v113
    v_cvt_pk_bf16_f32 v116, v112, v113
    v_lshlrev_b32 v112, 16, v116
    v_and_b32 v113, s72, v116
    v_sqrt_f32 v112, v112
    v_sqrt_f32 v113, v113
    s_nop 0
    v_cvt_pk_bf16_f32 v116, v112, v113
    v_lshlrev_b32 v112, 16, v116
    v_and_b32 v113, s72, v116
    v_rcp_f32 v91, v112
    v_rcp_f32 v95, v113
    s_nop 0
    v_fma_f32 v114, -v112, v91, 1.0
    v_fma_f32 v115, -v113, v95, 1.0
    v_fmac_f32 v91, v91, v114
    v_fmac_f32 v95, v95, v115
    v_mov_b32 v90, v91
    v_mov_b32 v94, v95
    v_pk_add_f32 v[96:97], v[72:73], v[88:89] neg_lo:[0,1] neg_hi:[0,1]
    v_pk_add_f32 v[98:99], v[74:75], v[88:89] neg_lo:[0,1] neg_hi:[0,1]
    v_pk_add_f32 v[100:101], v[76:77], v[88:89] neg_lo:[0,1] neg_hi:[0,1]
    v_pk_add_f32 v[102:103], v[78:79], v[88:89] neg_lo:[0,1] neg_hi:[0,1]
    v_cvt_pk_bf16_f32 v64, v96, v97
    v_cvt_pk_bf16_f32 v65, v98, v99
    v_cvt_pk_bf16_f32 v66, v100, v101
    v_cvt_pk_bf16_f32 v67, v102, v103
    v_lshlrev_b32 v96, 16, v64
    v_and_b32 v97, s72, v64
    v_lshlrev_b32 v98, 16, v65
    v_and_b32 v99, s72, v65
    v_lshlrev_b32 v100, 16, v66
    v_and_b32 v101, s72, v66
    v_lshlrev_b32 v102, 16, v67
    v_and_b32 v103, s72, v67
    v_pk_mul_f32 v[96:97], v[96:97], v[90:91]
    v_pk_mul_f32 v[98:99], v[98:99], v[90:91]
    v_pk_mul_f32 v[100:101], v[100:101], v[90:91]
    v_pk_mul_f32 v[102:103], v[102:103], v[90:91]
    v_cvt_pk_bf16_f32 v64, v96, v97
    v_cvt_pk_bf16_f32 v65, v98, v99
    v_cvt_pk_bf16_f32 v66, v100, v101
    v_cvt_pk_bf16_f32 v67, v102, v103
    v_lshlrev_b32 v96, 16, v64
    v_and_b32 v97, s72, v64
    v_lshlrev_b32 v98, 16, v65
    v_and_b32 v99, s72, v65
    v_lshlrev_b32 v100, 16, v66
    v_and_b32 v101, s72, v66
    v_lshlrev_b32 v102, 16, v67
    v_and_b32 v103, s72, v67
    v_cvt_pk_f16_f32 v120, v96, v97
    v_cvt_pk_f16_f32 v121, v98, v99
    v_cvt_pk_f16_f32 v122, v100, v101
    v_cvt_pk_f16_f32 v123, v102, v103
    v_pk_add_f32 v[104:105], v[80:81], v[92:93] neg_lo:[0,1] neg_hi:[0,1]
    v_pk_add_f32 v[106:107], v[82:83], v[92:93] neg_lo:[0,1] neg_hi:[0,1]
    v_pk_add_f32 v[108:109], v[84:85], v[92:93] neg_lo:[0,1] neg_hi:[0,1]
    v_pk_add_f32 v[110:111], v[86:87], v[92:93] neg_lo:[0,1] neg_hi:[0,1]
    v_cvt_pk_bf16_f32 v68, v104, v105
    v_cvt_pk_bf16_f32 v69, v106, v107
    v_cvt_pk_bf16_f32 v70, v108, v109
    v_cvt_pk_bf16_f32 v71, v110, v111
    v_lshlrev_b32 v104, 16, v68
    v_and_b32 v105, s72, v68
    v_lshlrev_b32 v106, 16, v69
    v_and_b32 v107, s72, v69
    v_lshlrev_b32 v108, 16, v70
    v_and_b32 v109, s72, v70
    v_lshlrev_b32 v110, 16, v71
    v_and_b32 v111, s72, v71
    v_pk_mul_f32 v[104:105], v[104:105], v[94:95]
    v_pk_mul_f32 v[106:107], v[106:107], v[94:95]
    v_pk_mul_f32 v[108:109], v[108:109], v[94:95]
    v_pk_mul_f32 v[110:111], v[110:111], v[94:95]
    v_cvt_pk_bf16_f32 v68, v104, v105
    v_cvt_pk_bf16_f32 v69, v106, v107
    v_cvt_pk_bf16_f32 v70, v108, v109
    v_cvt_pk_bf16_f32 v71, v110, v111
    v_lshlrev_b32 v104, 16, v68
    v_and_b32 v105, s72, v68
    v_lshlrev_b32 v106, 16, v69
    v_and_b32 v107, s72, v69
    v_lshlrev_b32 v108, 16, v70
    v_and_b32 v109, s72, v70
    v_lshlrev_b32 v110, 16, v71
    v_and_b32 v111, s72, v71
    v_cvt_pk_f16_f32 v124, v104, v105
    v_cvt_pk_f16_f32 v125, v106, v107
    v_cvt_pk_f16_f32 v126, v108, v109
    v_cvt_pk_f16_f32 v127, v110, v111
    s_mul_i32 s70, s60, 2080
    s_add_u32 s70, s70, 57344
    v_add_u32 v230, s70, v2
    ds_write_b128 v230, v[64:67] offset:0
    ds_write_b128 v230, v[120:123] offset:8320
    ds_write_b128 v230, v[68:71] offset:1040
    ds_write_b128 v230, v[124:127] offset:9360
    s_waitcnt lgkmcnt(0)
    s_mul_i32 s34, s35, 0x9E3779B1
    s_xor_b32 s34, s34, 0x85EBCA6B
    s_barrier
    s_cmp_ge_u32 s60, 2
    s_cbranch_scc1 FG_LNB
    v_and_b32 v230, 7, v1
    v_lshrrev_b32 v231, 5, v1
    v_bfe_u32 v232, v1, 3, 2
    v_mul_u32_u24 v233, 1040, v230
    v_lshl_add_u32 v233, v231, 6, v233
    v_lshl_add_u32 v233, v232, 3, v233
    s_lshl_b32 s70, s60, 9
    v_add_u32 v233, s70, v233
    v_lshlrev_b32 v234, 10, v231
    v_lshl_add_u32 v234, v232, 8, v234
    v_lshl_add_u32 v234, v230, 4, v234
    ds_read_b64 v[64:65], v233 offset:57344
    ds_read_b64 v[66:67], v233 offset:57376
    ds_read_b64 v[68:69], v233 offset:57472
    ds_read_b64 v[70:71], v233 offset:57504
    ds_read_b64 v[72:73], v233 offset:57600
    ds_read_b64 v[74:75], v233 offset:57632
    ds_read_b64 v[76:77], v233 offset:57728
    ds_read_b64 v[78:79], v233 offset:57760
    s_lshr_b32 s70, s2, 1
    s_lshl_b32 s70, s70, 14
    s_and_b32 s71, s2, 1
    s_lshl_b32 s71, s71, 7
    s_add_u32 s70, s70, s71
    s_lshl_b32 s71, s60, 13
    s_add_u32 s70, s70, s71
    s_waitcnt lgkmcnt(6)
    buffer_store_dwordx4 v[64:67], v234, s[44:47], s70 offen offset:0 sc1
    s_waitcnt lgkmcnt(4)
    buffer_store_dwordx4 v[68:71], v234, s[44:47], s70 offen offset:2048 sc1
    s_waitcnt lgkmcnt(2)
    s_add_u32 s70, s70, 4096
    buffer_store_dwordx4 v[72:75], v234, s[44:47], s70 offen offset:0 sc1
    s_waitcnt lgkmcnt(0)
    buffer_store_dwordx4 v[76:79], v234, s[44:47], s70 offen offset:2048 sc1
    s_branch FG_LNJ
FG_LNB:
    v_lshrrev_b32 v230, 4, v1
    v_bfe_u32 v231, v1, 2, 2
    v_and_b32 v232, 3, v1
    v_sub_u32 v231, 3, v231
    v_mul_u32_u24 v233, 1040, v231
    v_lshl_add_u32 v233, v230, 5, v233
    v_lshl_add_u32 v233, v232, 3, v233
    s_sub_u32 s71, s60, 2
    s_lshl_b32 s70, s71, 9
    s_add_u32 s70, s70, 65664
    v_add_u32 v233, s70, v233
    ds_read_b64_tr_b16 v[64:65], v233 offset:4160
    ds_read_b64_tr_b16 v[66:67], v233 offset:0
    ds_read_b64_tr_b16 v[68:69], v233 offset:4288
    ds_read_b64_tr_b16 v[70:71], v233 offset:128
    ds_read_b64_tr_b16 v[72:73], v233 offset:4416
    ds_read_b64_tr_b16 v[74:75], v233 offset:256
    ds_read_b64_tr_b16 v[76:77], v233 offset:4544
    ds_read_b64_tr_b16 v[78:79], v233 offset:384
    s_lshl_b32 s70, s2, 13
    s_lshl_b32 s71, s71, 12
    s_add_u32 s70, s70, s71
    s_waitcnt lgkmcnt(6)
    buffer_store_dwordx4 v[64:67], v2, s[48:51], s70 offen offset:0 sc1
    s_waitcnt lgkmcnt(4)
    buffer_store_dwordx4 v[68:71], v2, s[48:51], s70 offen offset:1024 sc1
    s_waitcnt lgkmcnt(2)
    buffer_store_dwordx4 v[72:75], v2, s[48:51], s70 offen offset:2048 sc1
    s_waitcnt lgkmcnt(0)
    buffer_store_dwordx4 v[76:79], v2, s[48:51], s70 offen offset:3072 sc1
FG_LNJ:
    s_waitcnt vmcnt(0)
    s_barrier
    s_cmp_eq_u32 s60, 0
    s_cbranch_scc0 FG_LNF
    s_lshl_b32 s70, s2, 7
    s_add_u32 s70, s70, 49152
    v_mov_b32 v230, 0
    v_mov_b32 v231, s34
    s_mov_b64 exec, 1
    buffer_store_dword v231, v230, s[52:55], s70 offen sc1
    s_lshl_b32 s70, s2, 2
    buffer_store_dword v231, v230, s[52:55], s70 offen sc1
    s_mov_b64 exec, -1
FG_LNF:
    s_add_u32 s68, s61, 458752
    s_add_u32 s70, s62, 28672
    s_mov_b32 m0, s70
    s_nop 0
    buffer_load_dwordx4 v60, s[40:43], s68 offen lds
    s_add_u32 s70, s62, 29696
    s_mov_b32 m0, s70
    s_nop 0
    buffer_load_dwordx4 v61, s[40:43], s68 offen lds
    s_add_u32 s70, s62, 30720
    s_mov_b32 m0, s70
    s_nop 0
    buffer_load_dwordx4 v62, s[40:43], s68 offen lds
    s_add_u32 s70, s62, 31744
    s_mov_b32 m0, s70
    s_mov_b32 exec_hi, 0
    buffer_load_dwordx4 v63, s[40:43], s68 offen lds
    s_mov_b64 exec, -1
    s_add_u32 s68, s61, 688128
    s_add_u32 s70, s62, 43008
    s_mov_b32 m0, s70
    s_nop 0
    buffer_load_dwordx4 v60, s[40:43], s68 offen lds
    s_add_u32 s70, s62, 44032
    s_mov_b32 m0, s70
    s_nop 0
    buffer_load_dwordx4 v61, s[40:43], s68 offen lds
    s_add_u32 s70, s62, 45056
    s_mov_b32 m0, s70
    s_nop 0
    buffer_load_dwordx4 v62, s[40:43], s68 offen lds
    s_add_u32 s70, s62, 46080
    s_mov_b32 m0, s70
    s_mov_b32 exec_hi, 0
    buffer_load_dwordx4 v63, s[40:43], s68 offen lds
    s_mov_b64 exec, -1
    s_add_u32 s68, s61, 917504
    s_add_u32 s70, s62, 57344
    s_mov_b32 m0, s70
    s_nop 0
    buffer_load_dwordx4 v60, s[40:43], s68 offen lds
    s_add_u32 s70, s62, 58368
    s_mov_b32 m0, s70
    s_nop 0
    buffer_load_dwordx4 v61, s[40:43], s68 offen lds
    s_add_u32 s70, s62, 59392
    s_mov_b32 m0, s70
    s_nop 0
    buffer_load_dwordx4 v62, s[40:43], s68 offen lds
    s_add_u32 s70, s62, 60416
    s_mov_b32 m0, s70
    s_mov_b32 exec_hi, 0
    buffer_load_dwordx4 v63, s[40:43], s68 offen lds
    s_mov_b64 exec, -1
    v_lshlrev_b32 v4, 16, v216
    v_and_b32 v5, s72, v216
    v_lshlrev_b32 v6, 16, v217
    v_and_b32 v7, s72, v217
    v_lshlrev_b32 v8, 16, v216
    v_and_b32 v9, s72, v216
    v_lshlrev_b32 v10, 16, v217
    v_and_b32 v11, s72, v217
    v_lshlrev_b32 v12, 16, v218
    v_and_b32 v13, s72, v218
    v_lshlrev_b32 v14, 16, v219
    v_and_b32 v15, s72, v219
    v_lshlrev_b32 v16, 16, v218
    v_and_b32 v17, s72, v218
    v_lshlrev_b32 v18, 16, v219
    v_and_b32 v19, s72, v219
    v_lshlrev_b32 v20, 16, v220
    v_and_b32 v21, s72, v220
    v_lshlrev_b32 v22, 16, v221
    v_and_b32 v23, s72, v221
    v_lshlrev_b32 v24, 16, v220
    v_and_b32 v25, s72, v220
    v_lshlrev_b32 v26, 16, v221
    v_and_b32 v27, s72, v221
    v_lshlrev_b32 v28, 16, v222
    v_and_b32 v29, s72, v222
    v_lshlrev_b32 v30, 16, v223
    v_and_b32 v31, s72, v223
    v_lshlrev_b32 v32, 16, v222
    v_and_b32 v33, s72, v222
    v_lshlrev_b32 v34, 16, v223
    v_and_b32 v35, s72, v223
    v_lshlrev_b32 v36, 16, v224
    v_and_b32 v37, s72, v224
    v_lshlrev_b32 v38, 16, v225
    v_and_b32 v39, s72, v225
    v_lshlrev_b32 v40, 16, v224
    v_and_b32 v41, s72, v224
    v_lshlrev_b32 v42, 16, v225
    v_and_b32 v43, s72, v225
    v_lshlrev_b32 v44, 16, v226
    v_and_b32 v45, s72, v226
    v_lshlrev_b32 v46, 16, v227
    v_and_b32 v47, s72, v227
    v_lshlrev_b32 v48, 16, v226
    v_and_b32 v49, s72, v226
    v_lshlrev_b32 v50, 16, v227
    v_and_b32 v51, s72, v227
    v_lshlrev_b32 v52, 16, v228
    v_and_b32 v53, s72, v228
    v_lshlrev_b32 v54, 16, v229
    v_and_b32 v55, s72, v229
    v_lshlrev_b32 v56, 16, v228
    v_and_b32 v57, s72, v228
    v_lshlrev_b32 v58, 16, v229
    v_and_b32 v59, s72, v229
    v_lshrrev_b32 v230, 2, v1
    v_mul_u32_u24 v3, 224, v230
    v_and_b32 v230, 3, v1
    v_lshl_add_u32 v3, v230, 3, v3
    v_add_u32 v248, 0x8000, v3
    v_lshlrev_b32 v245, 2, v1
    s_lshl_b32 s67, s63, 3
    s_lshl_b32 s70, s60, 1
    s_add_u32 s67, s67, s70
    s_lshl_b32 s73, s67, 14
    s_mov_b32 s48, s4
    s_mov_b32 s49, s5
    s_mov_b32 s50, 0x200000
    s_mov_b32 s51, 0x00020000
    s_lshl_b32 s70, s63, 11
    s_lshl_b32 s71, s60, 9
    s_add_u32 s70, s70, s71
    s_add_u32 s70, s70, 49152
    v_and_b32 v244, 3, v1
    v_lshlrev_b32 v244, 7, v244
    s_mov_b32 s76, 1048576
    s_mov_b32 s74, 0xf
    s_mov_b32 s75, 0
POLL_FG_1:
    buffer_load_dword v230, v244, s[52:55], s70 offen offset:0 sc1
    s_waitcnt vmcnt(0)
    v_xor_b32 v230, s34, v230
    v_cmp_ne_u32 vcc, 0, v230
    s_and_b64 vcc, vcc, s[74:75]
    s_cbranch_scc0 POLL_FG_1_D
    s_sleep 2
    s_sub_u32 s76, s76, 1
    s_cmp_lg_u32 s76, 0
    s_cbranch_scc1 POLL_FG_1
POLL_FG_1_D:
    s_add_u32 s70, s73, 0
    s_add_u32 s71, s73, 16384
    buffer_load_dwordx4 v[64:67], v2, s[44:47], s70 offen offset:0
    buffer_load_dwordx4 v[68:71], v2, s[44:47], s70 offen offset:1024
    buffer_load_dwordx4 v[72:75], v2, s[44:47], s71 offen offset:0
    buffer_load_dwordx4 v[76:79], v2, s[44:47], s71 offen offset:1024
    s_add_u32 s70, s73, 2048
    s_add_u32 s71, s73, 18432
    buffer_load_dwordx4 v[80:83], v2, s[44:47], s70 offen offset:0
    buffer_load_dwordx4 v[84:87], v2, s[44:47], s70 offen offset:1024
    buffer_load_dwordx4 v[88:91], v2, s[44:47], s71 offen offset:0
    buffer_load_dwordx4 v[92:95], v2, s[44:47], s71 offen offset:1024
    s_add_u32 s70, s73, 4096
    s_add_u32 s71, s73, 20480
    buffer_load_dwordx4 v[96:99], v2, s[44:47], s70 offen offset:0
    buffer_load_dwordx4 v[100:103], v2, s[44:47], s70 offen offset:1024
    buffer_load_dwordx4 v[104:107], v2, s[44:47], s71 offen offset:0
    buffer_load_dwordx4 v[108:111], v2, s[44:47], s71 offen offset:1024
    s_add_u32 s70, s73, 6144
    s_add_u32 s71, s73, 22528
    buffer_load_dwordx4 v[112:115], v2, s[44:47], s70 offen offset:0
    buffer_load_dwordx4 v[116:119], v2, s[44:47], s70 offen offset:1024
    buffer_load_dwordx4 v[120:123], v2, s[44:47], s71 offen offset:0
    buffer_load_dwordx4 v[124:127], v2, s[44:47], s71 offen offset:1024
    s_waitcnt vmcnt(12)
    s_barrier
    ds_read_b64_tr_b16 v[160:161], v3 offset:0
    ds_read_b64_tr_b16 v[162:163], v3 offset:3584
    ds_read_b64_tr_b16 v[164:165], v3 offset:32
    ds_read_b64_tr_b16 v[166:167], v3 offset:3616
    ds_read_b64_tr_b16 v[168:169], v3 offset:64
    ds_read_b64_tr_b16 v[170:171], v3 offset:3648
    ds_read_b64_tr_b16 v[172:173], v3 offset:96
    ds_read_b64_tr_b16 v[174:175], v3 offset:3680
    ds_read_b64_tr_b16 v[176:177], v3 offset:128
    ds_read_b64_tr_b16 v[178:179], v3 offset:3712
    ds_read_b64_tr_b16 v[180:181], v3 offset:160
    ds_read_b64_tr_b16 v[182:183], v3 offset:3744
    ds_read_b64_tr_b16 v[184:185], v3 offset:192
    ds_read_b64_tr_b16 v[186:187], v3 offset:3776
    s_waitcnt lgkmcnt(0)
    v_mfma_f32_16x16x32_bf16 v[4:7], v[160:163], v[64:67], v[4:7]
    ds_read_b64_tr_b16 v[188:189], v3 offset:7168
    v_mfma_f32_16x16x32_bf16 v[8:11], v[160:163], v[72:75], v[8:11]
    ds_read_b64_tr_b16 v[190:191], v3 offset:10752
    v_mfma_f32_16x16x32_bf16 v[12:15], v[164:167], v[64:67], v[12:15]
    ds_read_b64_tr_b16 v[192:193], v3 offset:7200
    v_mfma_f32_16x16x32_bf16 v[16:19], v[164:167], v[72:75], v[16:19]
    ds_read_b64_tr_b16 v[194:195], v3 offset:10784
    v_mfma_f32_16x16x32_bf16 v[20:23], v[168:171], v[64:67], v[20:23]
    ds_read_b64_tr_b16 v[196:197], v3 offset:7232
    v_mfma_f32_16x16x32_bf16 v[24:27], v[168:171], v[72:75], v[24:27]
    ds_read_b64_tr_b16 v[198:199], v3 offset:10816
    v_mfma_f32_16x16x32_bf16 v[28:31], v[172:175], v[64:67], v[28:31]
    ds_read_b64_tr_b16 v[200:201], v3 offset:7264
    v_mfma_f32_16x16x32_bf16 v[32:35], v[172:175], v[72:75], v[32:35]
    ds_read_b64_tr_b16 v[202:203], v3 offset:10848
    v_mfma_f32_16x16x32_bf16 v[36:39], v[176:179], v[64:67], v[36:39]
    ds_read_b64_tr_b16 v[204:205], v3 offset:7296
    v_mfma_f32_16x16x32_bf16 v[40:43], v[176:179], v[72:75], v[40:43]
    ds_read_b64_tr_b16 v[206:207], v3 offset:10880
    v_mfma_f32_16x16x32_bf16 v[44:47], v[180:183], v[64:67], v[44:47]
    ds_read_b64_tr_b16 v[208:209], v3 offset:7328
    v_mfma_f32_16x16x32_bf16 v[48:51], v[180:183], v[72:75], v[48:51]
    ds_read_b64_tr_b16 v[210:211], v3 offset:10912
    v_mfma_f32_16x16x32_bf16 v[52:55], v[184:187], v[64:67], v[52:55]
    ds_read_b64_tr_b16 v[212:213], v3 offset:7360
    v_mfma_f32_16x16x32_bf16 v[56:59], v[184:187], v[72:75], v[56:59]
    ds_read_b64_tr_b16 v[214:215], v3 offset:10944
    s_waitcnt vmcnt(8)
    s_barrier
    s_waitcnt lgkmcnt(0)
    v_mfma_f32_16x16x32_bf16 v[4:7], v[188:191], v[68:71], v[4:7]
    ds_read_b64_tr_b16 v[160:161], v3 offset:14336
    v_mfma_f32_16x16x32_bf16 v[8:11], v[188:191], v[76:79], v[8:11]
    ds_read_b64_tr_b16 v[162:163], v3 offset:17920
    v_mfma_f32_16x16x32_bf16 v[12:15], v[192:195], v[68:71], v[12:15]
    ds_read_b64_tr_b16 v[164:165], v3 offset:14368
    v_mfma_f32_16x16x32_bf16 v[16:19], v[192:195], v[76:79], v[16:19]
    ds_read_b64_tr_b16 v[166:167], v3 offset:17952
    v_mfma_f32_16x16x32_bf16 v[20:23], v[196:199], v[68:71], v[20:23]
    ds_read_b64_tr_b16 v[168:169], v3 offset:14400
    v_mfma_f32_16x16x32_bf16 v[24:27], v[196:199], v[76:79], v[24:27]
    ds_read_b64_tr_b16 v[170:171], v3 offset:17984
    v_mfma_f32_16x16x32_bf16 v[28:31], v[200:203], v[68:71], v[28:31]
    ds_read_b64_tr_b16 v[172:173], v3 offset:14432
    v_mfma_f32_16x16x32_bf16 v[32:35], v[200:203], v[76:79], v[32:35]
    ds_read_b64_tr_b16 v[174:175], v3 offset:18016
    v_mfma_f32_16x16x32_bf16 v[36:39], v[204:207], v[68:71], v[36:39]
    ds_read_b64_tr_b16 v[176:177], v3 offset:14464
    v_mfma_f32_16x16x32_bf16 v[40:43], v[204:207], v[76:79], v[40:43]
    ds_read_b64_tr_b16 v[178:179], v3 offset:18048
    v_mfma_f32_16x16x32_bf16 v[44:47], v[208:211], v[68:71], v[44:47]
    ds_read_b64_tr_b16 v[180:181], v3 offset:14496
    v_mfma_f32_16x16x32_bf16 v[48:51], v[208:211], v[76:79], v[48:51]
    ds_read_b64_tr_b16 v[182:183], v3 offset:18080
    v_mfma_f32_16x16x32_bf16 v[52:55], v[212:215], v[68:71], v[52:55]
    ds_read_b64_tr_b16 v[184:185], v3 offset:14528
    v_mfma_f32_16x16x32_bf16 v[56:59], v[212:215], v[76:79], v[56:59]
    ds_read_b64_tr_b16 v[186:187], v3 offset:18112
    s_add_u32 s70, s73, 8192
    s_add_u32 s71, s73, 24576
    buffer_load_dwordx4 v[128:131], v2, s[44:47], s70 offen offset:0
    buffer_load_dwordx4 v[132:135], v2, s[44:47], s70 offen offset:1024
    buffer_load_dwordx4 v[136:139], v2, s[44:47], s71 offen offset:0
    buffer_load_dwordx4 v[140:143], v2, s[44:47], s71 offen offset:1024
    s_waitcnt lgkmcnt(0)
    v_mfma_f32_16x16x32_bf16 v[4:7], v[160:163], v[80:83], v[4:7]
    ds_read_b64_tr_b16 v[188:189], v3 offset:21504
    v_mfma_f32_16x16x32_bf16 v[8:11], v[160:163], v[88:91], v[8:11]
    ds_read_b64_tr_b16 v[190:191], v3 offset:25088
    v_mfma_f32_16x16x32_bf16 v[12:15], v[164:167], v[80:83], v[12:15]
    ds_read_b64_tr_b16 v[192:193], v3 offset:21536
    v_mfma_f32_16x16x32_bf16 v[16:19], v[164:167], v[88:91], v[16:19]
    ds_read_b64_tr_b16 v[194:195], v3 offset:25120
    v_mfma_f32_16x16x32_bf16 v[20:23], v[168:171], v[80:83], v[20:23]
    ds_read_b64_tr_b16 v[196:197], v3 offset:21568
    v_mfma_f32_16x16x32_bf16 v[24:27], v[168:171], v[88:91], v[24:27]
    ds_read_b64_tr_b16 v[198:199], v3 offset:25152
    v_mfma_f32_16x16x32_bf16 v[28:31], v[172:175], v[80:83], v[28:31]
    ds_read_b64_tr_b16 v[200:201], v3 offset:21600
    v_mfma_f32_16x16x32_bf16 v[32:35], v[172:175], v[88:91], v[32:35]
    ds_read_b64_tr_b16 v[202:203], v3 offset:25184
    v_mfma_f32_16x16x32_bf16 v[36:39], v[176:179], v[80:83], v[36:39]
    ds_read_b64_tr_b16 v[204:205], v3 offset:21632
    v_mfma_f32_16x16x32_bf16 v[40:43], v[176:179], v[88:91], v[40:43]
    ds_read_b64_tr_b16 v[206:207], v3 offset:25216
    v_mfma_f32_16x16x32_bf16 v[44:47], v[180:183], v[80:83], v[44:47]
    ds_read_b64_tr_b16 v[208:209], v3 offset:21664
    v_mfma_f32_16x16x32_bf16 v[48:51], v[180:183], v[88:91], v[48:51]
    ds_read_b64_tr_b16 v[210:211], v3 offset:25248
    v_mfma_f32_16x16x32_bf16 v[52:55], v[184:187], v[80:83], v[52:55]
    ds_read_b64_tr_b16 v[212:213], v3 offset:21696
    v_mfma_f32_16x16x32_bf16 v[56:59], v[184:187], v[88:91], v[56:59]
    ds_read_b64_tr_b16 v[214:215], v3 offset:25280
    s_waitcnt vmcnt(8)
    s_barrier
    s_waitcnt lgkmcnt(0)
    v_mfma_f32_16x16x32_bf16 v[4:7], v[188:191], v[84:87], v[4:7]
    ds_read_b64_tr_b16 v[160:161], v3 offset:28672
    v_mfma_f32_16x16x32_bf16 v[8:11], v[188:191], v[92:95], v[8:11]
    ds_read_b64_tr_b16 v[162:163], v3 offset:32256
    v_mfma_f32_16x16x32_bf16 v[12:15], v[192:195], v[84:87], v[12:15]
    ds_read_b64_tr_b16 v[164:165], v3 offset:28704
    v_mfma_f32_16x16x32_bf16 v[16:19], v[192:195], v[92:95], v[16:19]
    ds_read_b64_tr_b16 v[166:167], v3 offset:32288
    v_mfma_f32_16x16x32_bf16 v[20:23], v[196:199], v[84:87], v[20:23]
    ds_read_b64_tr_b16 v[168:169], v3 offset:28736
    v_mfma_f32_16x16x32_bf16 v[24:27], v[196:199], v[92:95], v[24:27]
    ds_read_b64_tr_b16 v[170:171], v3 offset:32320
    v_mfma_f32_16x16x32_bf16 v[28:31], v[200:203], v[84:87], v[28:31]
    ds_read_b64_tr_b16 v[172:173], v3 offset:28768
    v_mfma_f32_16x16x32_bf16 v[32:35], v[200:203], v[92:95], v[32:35]
    ds_read_b64_tr_b16 v[174:175], v3 offset:32352
    v_mfma_f32_16x16x32_bf16 v[36:39], v[204:207], v[84:87], v[36:39]
    ds_read_b64_tr_b16 v[176:177], v3 offset:28800
    v_mfma_f32_16x16x32_bf16 v[40:43], v[204:207], v[92:95], v[40:43]
    ds_read_b64_tr_b16 v[178:179], v3 offset:32384
    v_mfma_f32_16x16x32_bf16 v[44:47], v[208:211], v[84:87], v[44:47]
    ds_read_b64_tr_b16 v[180:181], v3 offset:28832
    v_mfma_f32_16x16x32_bf16 v[48:51], v[208:211], v[92:95], v[48:51]
    ds_read_b64_tr_b16 v[182:183], v3 offset:32416
    v_mfma_f32_16x16x32_bf16 v[52:55], v[212:215], v[84:87], v[52:55]
    ds_read_b64_tr_b16 v[184:185], v3 offset:28864
    v_mfma_f32_16x16x32_bf16 v[56:59], v[212:215], v[92:95], v[56:59]
    ds_read_b64_tr_b16 v[186:187], v3 offset:32448
    s_add_u32 s68, s61, 1146880
    s_add_u32 s70, s62, 0
    s_mov_b32 m0, s70
    s_nop 0
    buffer_load_dwordx4 v60, s[40:43], s68 offen lds
    s_add_u32 s70, s62, 1024
    s_mov_b32 m0, s70
    s_nop 0
    buffer_load_dwordx4 v61, s[40:43], s68 offen lds
    s_add_u32 s70, s62, 2048
    s_mov_b32 m0, s70
    s_nop 0
    buffer_load_dwordx4 v62, s[40:43], s68 offen lds
    s_add_u32 s70, s62, 3072
    s_mov_b32 m0, s70
    s_mov_b32 exec_hi, 0
    buffer_load_dwordx4 v63, s[40:43], s68 offen lds
    s_mov_b64 exec, -1
    s_add_u32 s70, s73, 10240
    s_add_u32 s71, s73, 26624
    buffer_load_dwordx4 v[144:147], v2, s[44:47], s70 offen offset:0
    buffer_load_dwordx4 v[148:151], v2, s[44:47], s70 offen offset:1024
    buffer_load_dwordx4 v[152:155], v2, s[44:47], s71 offen offset:0
    buffer_load_dwordx4 v[156:159], v2, s[44:47], s71 offen offset:1024
    s_waitcnt lgkmcnt(0)
    v_mfma_f32_16x16x32_bf16 v[4:7], v[160:163], v[96:99], v[4:7]
    ds_read_b64_tr_b16 v[188:189], v248 offset:3072
    v_mfma_f32_16x16x32_bf16 v[8:11], v[160:163], v[104:107], v[8:11]
    ds_read_b64_tr_b16 v[190:191], v248 offset:6656
    v_mfma_f32_16x16x32_bf16 v[12:15], v[164:167], v[96:99], v[12:15]
    ds_read_b64_tr_b16 v[192:193], v248 offset:3104
    v_mfma_f32_16x16x32_bf16 v[16:19], v[164:167], v[104:107], v[16:19]
    ds_read_b64_tr_b16 v[194:195], v248 offset:6688
    v_mfma_f32_16x16x32_bf16 v[20:23], v[168:171], v[96:99], v[20:23]
    ds_read_b64_tr_b16 v[196:197], v248 offset:3136
    v_mfma_f32_16x16x32_bf16 v[24:27], v[168:171], v[104:107], v[24:27]
    ds_read_b64_tr_b16 v[198:199], v248 offset:6720
    v_mfma_f32_16x16x32_bf16 v[28:31], v[172:175], v[96:99], v[28:31]
    ds_read_b64_tr_b16 v[200:201], v248 offset:3168
    v_mfma_f32_16x16x32_bf16 v[32:35], v[172:175], v[104:107], v[32:35]
    ds_read_b64_tr_b16 v[202:203], v248 offset:6752
    v_mfma_f32_16x16x32_bf16 v[36:39], v[176:179], v[96:99], v[36:39]
    ds_read_b64_tr_b16 v[204:205], v248 offset:3200
    v_mfma_f32_16x16x32_bf16 v[40:43], v[176:179], v[104:107], v[40:43]
    ds_read_b64_tr_b16 v[206:207], v248 offset:6784
    v_mfma_f32_16x16x32_bf16 v[44:47], v[180:183], v[96:99], v[44:47]
    ds_read_b64_tr_b16 v[208:209], v248 offset:3232
    v_mfma_f32_16x16x32_bf16 v[48:51], v[180:183], v[104:107], v[48:51]
    ds_read_b64_tr_b16 v[210:211], v248 offset:6816
    v_mfma_f32_16x16x32_bf16 v[52:55], v[184:187], v[96:99], v[52:55]
    ds_read_b64_tr_b16 v[212:213], v248 offset:3264
    v_mfma_f32_16x16x32_bf16 v[56:59], v[184:187], v[104:107], v[56:59]
    ds_read_b64_tr_b16 v[214:215], v248 offset:6848
    s_waitcnt vmcnt(12)
    s_barrier
    s_waitcnt lgkmcnt(0)
    v_mfma_f32_16x16x32_bf16 v[4:7], v[188:191], v[100:103], v[4:7]
    ds_read_b64_tr_b16 v[160:161], v248 offset:10240
    v_mfma_f32_16x16x32_bf16 v[8:11], v[188:191], v[108:111], v[8:11]
    ds_read_b64_tr_b16 v[162:163], v248 offset:13824
    v_mfma_f32_16x16x32_bf16 v[12:15], v[192:195], v[100:103], v[12:15]
    ds_read_b64_tr_b16 v[164:165], v248 offset:10272
    v_mfma_f32_16x16x32_bf16 v[16:19], v[192:195], v[108:111], v[16:19]
    ds_read_b64_tr_b16 v[166:167], v248 offset:13856
    v_mfma_f32_16x16x32_bf16 v[20:23], v[196:199], v[100:103], v[20:23]
    ds_read_b64_tr_b16 v[168:169], v248 offset:10304
    v_mfma_f32_16x16x32_bf16 v[24:27], v[196:199], v[108:111], v[24:27]
    ds_read_b64_tr_b16 v[170:171], v248 offset:13888
    v_mfma_f32_16x16x32_bf16 v[28:31], v[200:203], v[100:103], v[28:31]
    ds_read_b64_tr_b16 v[172:173], v248 offset:10336
    v_mfma_f32_16x16x32_bf16 v[32:35], v[200:203], v[108:111], v[32:35]
    ds_read_b64_tr_b16 v[174:175], v248 offset:13920
    v_mfma_f32_16x16x32_bf16 v[36:39], v[204:207], v[100:103], v[36:39]
    ds_read_b64_tr_b16 v[176:177], v248 offset:10368
    v_mfma_f32_16x16x32_bf16 v[40:43], v[204:207], v[108:111], v[40:43]
    ds_read_b64_tr_b16 v[178:179], v248 offset:13952
    v_mfma_f32_16x16x32_bf16 v[44:47], v[208:211], v[100:103], v[44:47]
    ds_read_b64_tr_b16 v[180:181], v248 offset:10400
    v_mfma_f32_16x16x32_bf16 v[48:51], v[208:211], v[108:111], v[48:51]
    ds_read_b64_tr_b16 v[182:183], v248 offset:13984
    v_mfma_f32_16x16x32_bf16 v[52:55], v[212:215], v[100:103], v[52:55]
    ds_read_b64_tr_b16 v[184:185], v248 offset:10432
    v_mfma_f32_16x16x32_bf16 v[56:59], v[212:215], v[108:111], v[56:59]
    ds_read_b64_tr_b16 v[186:187], v248 offset:14016
    s_add_u32 s68, s61, 1376256
    s_add_u32 s70, s62, 14336
    s_mov_b32 m0, s70
    s_nop 0
    buffer_load_dwordx4 v60, s[40:43], s68 offen lds
    s_add_u32 s70, s62, 15360
    s_mov_b32 m0, s70
    s_nop 0
    buffer_load_dwordx4 v61, s[40:43], s68 offen lds
    s_add_u32 s70, s62, 16384
    s_mov_b32 m0, s70
    s_nop 0
    buffer_load_dwordx4 v62, s[40:43], s68 offen lds
    s_add_u32 s70, s62, 17408
    s_mov_b32 m0, s70
    s_mov_b32 exec_hi, 0
    buffer_load_dwordx4 v63, s[40:43], s68 offen lds
    s_mov_b64 exec, -1
    s_add_u32 s70, s73, 12288
    s_add_u32 s71, s73, 28672
    buffer_load_dwordx4 v[64:67], v2, s[44:47], s70 offen offset:0
    buffer_load_dwordx4 v[68:71], v2, s[44:47], s70 offen offset:1024
    buffer_load_dwordx4 v[72:75], v2, s[44:47], s71 offen offset:0
    buffer_load_dwordx4 v[76:79], v2, s[44:47], s71 offen offset:1024
    s_waitcnt lgkmcnt(0)
    v_mfma_f32_16x16x32_bf16 v[4:7], v[160:163], v[112:115], v[4:7]
    ds_read_b64_tr_b16 v[188:189], v248 offset:17408
    v_mfma_f32_16x16x32_bf16 v[8:11], v[160:163], v[120:123], v[8:11]
    ds_read_b64_tr_b16 v[190:191], v248 offset:20992
    v_mfma_f32_16x16x32_bf16 v[12:15], v[164:167], v[112:115], v[12:15]
    ds_read_b64_tr_b16 v[192:193], v248 offset:17440
    v_mfma_f32_16x16x32_bf16 v[16:19], v[164:167], v[120:123], v[16:19]
    ds_read_b64_tr_b16 v[194:195], v248 offset:21024
    v_mfma_f32_16x16x32_bf16 v[20:23], v[168:171], v[112:115], v[20:23]
    ds_read_b64_tr_b16 v[196:197], v248 offset:17472
    v_mfma_f32_16x16x32_bf16 v[24:27], v[168:171], v[120:123], v[24:27]
    ds_read_b64_tr_b16 v[198:199], v248 offset:21056
    v_mfma_f32_16x16x32_bf16 v[28:31], v[172:175], v[112:115], v[28:31]
    ds_read_b64_tr_b16 v[200:201], v248 offset:17504
    v_mfma_f32_16x16x32_bf16 v[32:35], v[172:175], v[120:123], v[32:35]
    ds_read_b64_tr_b16 v[202:203], v248 offset:21088
    v_mfma_f32_16x16x32_bf16 v[36:39], v[176:179], v[112:115], v[36:39]
    ds_read_b64_tr_b16 v[204:205], v248 offset:17536
    v_mfma_f32_16x16x32_bf16 v[40:43], v[176:179], v[120:123], v[40:43]
    ds_read_b64_tr_b16 v[206:207], v248 offset:21120
    v_mfma_f32_16x16x32_bf16 v[44:47], v[180:183], v[112:115], v[44:47]
    ds_read_b64_tr_b16 v[208:209], v248 offset:17568
    v_mfma_f32_16x16x32_bf16 v[48:51], v[180:183], v[120:123], v[48:51]
    ds_read_b64_tr_b16 v[210:211], v248 offset:21152
    v_mfma_f32_16x16x32_bf16 v[52:55], v[184:187], v[112:115], v[52:55]
    ds_read_b64_tr_b16 v[212:213], v248 offset:17600
    v_mfma_f32_16x16x32_bf16 v[56:59], v[184:187], v[120:123], v[56:59]
    ds_read_b64_tr_b16 v[214:215], v248 offset:21184
    s_waitcnt vmcnt(16)
    s_barrier
    s_waitcnt lgkmcnt(0)
    v_mfma_f32_16x16x32_bf16 v[4:7], v[188:191], v[116:119], v[4:7]
    ds_read_b64_tr_b16 v[160:161], v248 offset:24576
    v_mfma_f32_16x16x32_bf16 v[8:11], v[188:191], v[124:127], v[8:11]
    ds_read_b64_tr_b16 v[162:163], v248 offset:28160
    v_mfma_f32_16x16x32_bf16 v[12:15], v[192:195], v[116:119], v[12:15]
    ds_read_b64_tr_b16 v[164:165], v248 offset:24608
    v_mfma_f32_16x16x32_bf16 v[16:19], v[192:195], v[124:127], v[16:19]
    ds_read_b64_tr_b16 v[166:167], v248 offset:28192
    v_mfma_f32_16x16x32_bf16 v[20:23], v[196:199], v[116:119], v[20:23]
    ds_read_b64_tr_b16 v[168:169], v248 offset:24640
    v_mfma_f32_16x16x32_bf16 v[24:27], v[196:199], v[124:127], v[24:27]
    ds_read_b64_tr_b16 v[170:171], v248 offset:28224
    v_mfma_f32_16x16x32_bf16 v[28:31], v[200:203], v[116:119], v[28:31]
    ds_read_b64_tr_b16 v[172:173], v248 offset:24672
    v_mfma_f32_16x16x32_bf16 v[32:35], v[200:203], v[124:127], v[32:35]
    ds_read_b64_tr_b16 v[174:175], v248 offset:28256
    v_mfma_f32_16x16x32_bf16 v[36:39], v[204:207], v[116:119], v[36:39]
    ds_read_b64_tr_b16 v[176:177], v248 offset:24704
    v_mfma_f32_16x16x32_bf16 v[40:43], v[204:207], v[124:127], v[40:43]
    ds_read_b64_tr_b16 v[178:179], v248 offset:28288
    v_mfma_f32_16x16x32_bf16 v[44:47], v[208:211], v[116:119], v[44:47]
    ds_read_b64_tr_b16 v[180:181], v248 offset:24736
    v_mfma_f32_16x16x32_bf16 v[48:51], v[208:211], v[124:127], v[48:51]
    ds_read_b64_tr_b16 v[182:183], v248 offset:28320
    v_mfma_f32_16x16x32_bf16 v[52:55], v[212:215], v[116:119], v[52:55]
    ds_read_b64_tr_b16 v[184:185], v248 offset:24768
    v_mfma_f32_16x16x32_bf16 v[56:59], v[212:215], v[124:127], v[56:59]
    ds_read_b64_tr_b16 v[186:187], v248 offset:28352
    s_add_u32 s68, s61, 1605632
    s_add_u32 s70, s62, 28672
    s_mov_b32 m0, s70
    s_nop 0
    buffer_load_dwordx4 v60, s[40:43], s68 offen lds
    s_add_u32 s70, s62, 29696
    s_mov_b32 m0, s70
    s_nop 0
    buffer_load_dwordx4 v61, s[40:43], s68 offen lds
    s_add_u32 s70, s62, 30720
    s_mov_b32 m0, s70
    s_nop 0
    buffer_load_dwordx4 v62, s[40:43], s68 offen lds
    s_add_u32 s70, s62, 31744
    s_mov_b32 m0, s70
    s_mov_b32 exec_hi, 0
    buffer_load_dwordx4 v63, s[40:43], s68 offen lds
    s_mov_b64 exec, -1
    s_add_u32 s70, s73, 14336
    s_add_u32 s71, s73, 30720
    buffer_load_dwordx4 v[80:83], v2, s[44:47], s70 offen offset:0
    buffer_load_dwordx4 v[84:87], v2, s[44:47], s70 offen offset:1024
    buffer_load_dwordx4 v[88:91], v2, s[44:47], s71 offen offset:0
    buffer_load_dwordx4 v[92:95], v2, s[44:47], s71 offen offset:1024
    s_waitcnt lgkmcnt(0)
    v_mfma_f32_16x16x32_bf16 v[4:7], v[160:163], v[128:131], v[4:7]
    ds_read_b64_tr_b16 v[188:189], v248 offset:31744
    v_mfma_f32_16x16x32_bf16 v[8:11], v[160:163], v[136:139], v[8:11]
    ds_read_b64_tr_b16 v[190:191], v248 offset:35328
    v_mfma_f32_16x16x32_bf16 v[12:15], v[164:167], v[128:131], v[12:15]
    ds_read_b64_tr_b16 v[192:193], v248 offset:31776
    v_mfma_f32_16x16x32_bf16 v[16:19], v[164:167], v[136:139], v[16:19]
    ds_read_b64_tr_b16 v[194:195], v248 offset:35360
    v_mfma_f32_16x16x32_bf16 v[20:23], v[168:171], v[128:131], v[20:23]
    ds_read_b64_tr_b16 v[196:197], v248 offset:31808
    v_mfma_f32_16x16x32_bf16 v[24:27], v[168:171], v[136:139], v[24:27]
    ds_read_b64_tr_b16 v[198:199], v248 offset:35392
    v_mfma_f32_16x16x32_bf16 v[28:31], v[172:175], v[128:131], v[28:31]
    ds_read_b64_tr_b16 v[200:201], v248 offset:31840
    v_mfma_f32_16x16x32_bf16 v[32:35], v[172:175], v[136:139], v[32:35]
    ds_read_b64_tr_b16 v[202:203], v248 offset:35424
    v_mfma_f32_16x16x32_bf16 v[36:39], v[176:179], v[128:131], v[36:39]
    ds_read_b64_tr_b16 v[204:205], v248 offset:31872
    v_mfma_f32_16x16x32_bf16 v[40:43], v[176:179], v[136:139], v[40:43]
    ds_read_b64_tr_b16 v[206:207], v248 offset:35456
    v_mfma_f32_16x16x32_bf16 v[44:47], v[180:183], v[128:131], v[44:47]
    ds_read_b64_tr_b16 v[208:209], v248 offset:31904
    v_mfma_f32_16x16x32_bf16 v[48:51], v[180:183], v[136:139], v[48:51]
    ds_read_b64_tr_b16 v[210:211], v248 offset:35488
    v_mfma_f32_16x16x32_bf16 v[52:55], v[184:187], v[128:131], v[52:55]
    ds_read_b64_tr_b16 v[212:213], v248 offset:31936
    v_mfma_f32_16x16x32_bf16 v[56:59], v[184:187], v[136:139], v[56:59]
    ds_read_b64_tr_b16 v[214:215], v248 offset:35520
    s_waitcnt vmcnt(16)
    s_barrier
    s_waitcnt lgkmcnt(0)
    v_mfma_f32_16x16x32_bf16 v[4:7], v[188:191], v[132:135], v[4:7]
    ds_read_b64_tr_b16 v[160:161], v3 offset:0
    v_mfma_f32_16x16x32_bf16 v[8:11], v[188:191], v[140:143], v[8:11]
    ds_read_b64_tr_b16 v[162:163], v3 offset:3584
    v_mfma_f32_16x16x32_bf16 v[12:15], v[192:195], v[132:135], v[12:15]
    ds_read_b64_tr_b16 v[164:165], v3 offset:32
    v_mfma_f32_16x16x32_bf16 v[16:19], v[192:195], v[140:143], v[16:19]
    ds_read_b64_tr_b16 v[166:167], v3 offset:3616
    v_mfma_f32_16x16x32_bf16 v[20:23], v[196:199], v[132:135], v[20:23]
    ds_read_b64_tr_b16 v[168:169], v3 offset:64
    v_mfma_f32_16x16x32_bf16 v[24:27], v[196:199], v[140:143], v[24:27]
    ds_read_b64_tr_b16 v[170:171], v3 offset:3648
    v_mfma_f32_16x16x32_bf16 v[28:31], v[200:203], v[132:135], v[28:31]
    ds_read_b64_tr_b16 v[172:173], v3 offset:96
    v_mfma_f32_16x16x32_bf16 v[32:35], v[200:203], v[140:143], v[32:35]
    ds_read_b64_tr_b16 v[174:175], v3 offset:3680
    v_mfma_f32_16x16x32_bf16 v[36:39], v[204:207], v[132:135], v[36:39]
    ds_read_b64_tr_b16 v[176:177], v3 offset:128
    v_mfma_f32_16x16x32_bf16 v[40:43], v[204:207], v[140:143], v[40:43]
    ds_read_b64_tr_b16 v[178:179], v3 offset:3712
    v_mfma_f32_16x16x32_bf16 v[44:47], v[208:211], v[132:135], v[44:47]
    ds_read_b64_tr_b16 v[180:181], v3 offset:160
    v_mfma_f32_16x16x32_bf16 v[48:51], v[208:211], v[140:143], v[48:51]
    ds_read_b64_tr_b16 v[182:183], v3 offset:3744
    v_mfma_f32_16x16x32_bf16 v[52:55], v[212:215], v[132:135], v[52:55]
    ds_read_b64_tr_b16 v[184:185], v3 offset:192
    v_mfma_f32_16x16x32_bf16 v[56:59], v[212:215], v[140:143], v[56:59]
    ds_read_b64_tr_b16 v[186:187], v3 offset:3776
    v_lshrrev_b32 v231, 3, v1
    v_and_b32 v232, 7, v1
    v_lshlrev_b32 v233, 10, v231
    v_lshl_add_u32 v233, v232, 4, v233
    v_lshlrev_b32 v249, 12, v231
    v_lshl_add_u32 v249, v232, 4, v249
    s_lshl_b32 s70, s65, 16
    s_lshl_b32 s71, s60, 14
    s_add_u32 s70, s70, s71
    s_lshl_b32 s71, s66, 7
    s_add_u32 s70, s70, s71
    s_lshl_b32 s71, s60, 11
    s_add_u32 s71, s71, 73728
    s_mov_b32 m0, s71
    s_nop 0
    buffer_load_dwordx4 v233, s[48:51], s70 offen lds
    s_add_u32 s70, s70, 8192
    s_add_u32 s71, s71, 1024
    s_mov_b32 m0, s71
    s_nop 0
    buffer_load_dwordx4 v233, s[48:51], s70 offen lds
    s_lshl_b32 s70, s66, 7
    buffer_load_dwordx2 v[236:237], v235, s[56:59], s70 offen offset:0
    buffer_load_dwordx2 v[238:239], v235, s[56:59], s70 offen offset:32
    buffer_load_dwordx2 v[240:241], v235, s[56:59], s70 offen offset:64
    buffer_load_dwordx2 v[242:243], v235, s[56:59], s70 offen offset:96
    s_waitcnt lgkmcnt(0)
    v_mfma_f32_16x16x32_bf16 v[4:7], v[160:163], v[144:147], v[4:7]
    ds_read_b64_tr_b16 v[188:189], v3 offset:7168
    v_mfma_f32_16x16x32_bf16 v[8:11], v[160:163], v[152:155], v[8:11]
    ds_read_b64_tr_b16 v[190:191], v3 offset:10752
    v_mfma_f32_16x16x32_bf16 v[12:15], v[164:167], v[144:147], v[12:15]
    ds_read_b64_tr_b16 v[192:193], v3 offset:7200
    v_mfma_f32_16x16x32_bf16 v[16:19], v[164:167], v[152:155], v[16:19]
    ds_read_b64_tr_b16 v[194:195], v3 offset:10784
    v_mfma_f32_16x16x32_bf16 v[20:23], v[168:171], v[144:147], v[20:23]
    ds_read_b64_tr_b16 v[196:197], v3 offset:7232
    v_mfma_f32_16x16x32_bf16 v[24:27], v[168:171], v[152:155], v[24:27]
    ds_read_b64_tr_b16 v[198:199], v3 offset:10816
    v_mfma_f32_16x16x32_bf16 v[28:31], v[172:175], v[144:147], v[28:31]
    ds_read_b64_tr_b16 v[200:201], v3 offset:7264
    v_mfma_f32_16x16x32_bf16 v[32:35], v[172:175], v[152:155], v[32:35]
    ds_read_b64_tr_b16 v[202:203], v3 offset:10848
    v_mfma_f32_16x16x32_bf16 v[36:39], v[176:179], v[144:147], v[36:39]
    ds_read_b64_tr_b16 v[204:205], v3 offset:7296
    v_mfma_f32_16x16x32_bf16 v[40:43], v[176:179], v[152:155], v[40:43]
    ds_read_b64_tr_b16 v[206:207], v3 offset:10880
    v_mfma_f32_16x16x32_bf16 v[44:47], v[180:183], v[144:147], v[44:47]
    ds_read_b64_tr_b16 v[208:209], v3 offset:7328
    v_mfma_f32_16x16x32_bf16 v[48:51], v[180:183], v[152:155], v[48:51]
    ds_read_b64_tr_b16 v[210:211], v3 offset:10912
    v_mfma_f32_16x16x32_bf16 v[52:55], v[184:187], v[144:147], v[52:55]
    ds_read_b64_tr_b16 v[212:213], v3 offset:7360
    v_mfma_f32_16x16x32_bf16 v[56:59], v[184:187], v[152:155], v[56:59]
    ds_read_b64_tr_b16 v[214:215], v3 offset:10944
    s_waitcnt vmcnt(14)
    s_barrier
    s_waitcnt lgkmcnt(0)
    v_mfma_f32_16x16x32_bf16 v[4:7], v[188:191], v[148:151], v[4:7]
    ds_read_b64_tr_b16 v[160:161], v3 offset:14336
    v_mfma_f32_16x16x32_bf16 v[8:11], v[188:191], v[156:159], v[8:11]
    ds_read_b64_tr_b16 v[162:163], v3 offset:17920
    v_mfma_f32_16x16x32_bf16 v[12:15], v[192:195], v[148:151], v[12:15]
    ds_read_b64_tr_b16 v[164:165], v3 offset:14368
    v_mfma_f32_16x16x32_bf16 v[16:19], v[192:195], v[156:159], v[16:19]
    ds_read_b64_tr_b16 v[166:167], v3 offset:17952
    v_mfma_f32_16x16x32_bf16 v[20:23], v[196:199], v[148:151], v[20:23]
    ds_read_b64_tr_b16 v[168:169], v3 offset:14400
    v_mfma_f32_16x16x32_bf16 v[24:27], v[196:199], v[156:159], v[24:27]
    ds_read_b64_tr_b16 v[170:171], v3 offset:17984
    v_mfma_f32_16x16x32_bf16 v[28:31], v[200:203], v[148:151], v[28:31]
    ds_read_b64_tr_b16 v[172:173], v3 offset:14432
    v_mfma_f32_16x16x32_bf16 v[32:35], v[200:203], v[156:159], v[32:35]
    ds_read_b64_tr_b16 v[174:175], v3 offset:18016
    v_mfma_f32_16x16x32_bf16 v[36:39], v[204:207], v[148:151], v[36:39]
    ds_read_b64_tr_b16 v[176:177], v3 offset:14464
    v_mfma_f32_16x16x32_bf16 v[40:43], v[204:207], v[156:159], v[40:43]
    ds_read_b64_tr_b16 v[178:179], v3 offset:18048
    v_mfma_f32_16x16x32_bf16 v[44:47], v[208:211], v[148:151], v[44:47]
    ds_read_b64_tr_b16 v[180:181], v3 offset:14496
    v_mfma_f32_16x16x32_bf16 v[48:51], v[208:211], v[156:159], v[48:51]
    ds_read_b64_tr_b16 v[182:183], v3 offset:18080
    v_mfma_f32_16x16x32_bf16 v[52:55], v[212:215], v[148:151], v[52:55]
    ds_read_b64_tr_b16 v[184:185], v3 offset:14528
    v_mfma_f32_16x16x32_bf16 v[56:59], v[212:215], v[156:159], v[56:59]
    ds_read_b64_tr_b16 v[186:187], v3 offset:18112
    s_waitcnt lgkmcnt(0)
    v_mfma_f32_16x16x32_bf16 v[4:7], v[160:163], v[64:67], v[4:7]
    ds_read_b64_tr_b16 v[188:189], v3 offset:21504
    v_mfma_f32_16x16x32_bf16 v[8:11], v[160:163], v[72:75], v[8:11]
    ds_read_b64_tr_b16 v[190:191], v3 offset:25088
    v_mfma_f32_16x16x32_bf16 v[12:15], v[164:167], v[64:67], v[12:15]
    ds_read_b64_tr_b16 v[192:193], v3 offset:21536
    v_mfma_f32_16x16x32_bf16 v[16:19], v[164:167], v[72:75], v[16:19]
    ds_read_b64_tr_b16 v[194:195], v3 offset:25120
    v_mfma_f32_16x16x32_bf16 v[20:23], v[168:171], v[64:67], v[20:23]
    ds_read_b64_tr_b16 v[196:197], v3 offset:21568
    v_mfma_f32_16x16x32_bf16 v[24:27], v[168:171], v[72:75], v[24:27]
    ds_read_b64_tr_b16 v[198:199], v3 offset:25152
    v_mfma_f32_16x16x32_bf16 v[28:31], v[172:175], v[64:67], v[28:31]
    ds_read_b64_tr_b16 v[200:201], v3 offset:21600
    v_mfma_f32_16x16x32_bf16 v[32:35], v[172:175], v[72:75], v[32:35]
    ds_read_b64_tr_b16 v[202:203], v3 offset:25184
    v_mfma_f32_16x16x32_bf16 v[36:39], v[176:179], v[64:67], v[36:39]
    ds_read_b64_tr_b16 v[204:205], v3 offset:21632
    v_mfma_f32_16x16x32_bf16 v[40:43], v[176:179], v[72:75], v[40:43]
    ds_read_b64_tr_b16 v[206:207], v3 offset:25216
    v_mfma_f32_16x16x32_bf16 v[44:47], v[180:183], v[64:67], v[44:47]
    ds_read_b64_tr_b16 v[208:209], v3 offset:21664
    v_mfma_f32_16x16x32_bf16 v[48:51], v[180:183], v[72:75], v[48:51]
    ds_read_b64_tr_b16 v[210:211], v3 offset:25248
    v_mfma_f32_16x16x32_bf16 v[52:55], v[184:187], v[64:67], v[52:55]
    ds_read_b64_tr_b16 v[212:213], v3 offset:21696
    v_mfma_f32_16x16x32_bf16 v[56:59], v[184:187], v[72:75], v[56:59]
    ds_read_b64_tr_b16 v[214:215], v3 offset:25280
    s_waitcnt vmcnt(6)
    s_barrier
    s_waitcnt lgkmcnt(0)
    v_mfma_f32_16x16x32_bf16 v[4:7], v[188:191], v[68:71], v[4:7]
    ds_read_b64_tr_b16 v[160:161], v3 offset:28672
    v_mfma_f32_16x16x32_bf16 v[8:11], v[188:191], v[76:79], v[8:11]
    ds_read_b64_tr_b16 v[162:163], v3 offset:32256
    v_mfma_f32_16x16x32_bf16 v[12:15], v[192:195], v[68:71], v[12:15]
    ds_read_b64_tr_b16 v[164:165], v3 offset:28704
    v_mfma_f32_16x16x32_bf16 v[16:19], v[192:195], v[76:79], v[16:19]
    ds_read_b64_tr_b16 v[166:167], v3 offset:32288
    v_mfma_f32_16x16x32_bf16 v[20:23], v[196:199], v[68:71], v[20:23]
    ds_read_b64_tr_b16 v[168:169], v3 offset:28736
    v_mfma_f32_16x16x32_bf16 v[24:27], v[196:199], v[76:79], v[24:27]
    ds_read_b64_tr_b16 v[170:171], v3 offset:32320
    v_mfma_f32_16x16x32_bf16 v[28:31], v[200:203], v[68:71], v[28:31]
    ds_read_b64_tr_b16 v[172:173], v3 offset:28768
    v_mfma_f32_16x16x32_bf16 v[32:35], v[200:203], v[76:79], v[32:35]
    ds_read_b64_tr_b16 v[174:175], v3 offset:32352
    v_mfma_f32_16x16x32_bf16 v[36:39], v[204:207], v[68:71], v[36:39]
    ds_read_b64_tr_b16 v[176:177], v3 offset:28800
    v_mfma_f32_16x16x32_bf16 v[40:43], v[204:207], v[76:79], v[40:43]
    ds_read_b64_tr_b16 v[178:179], v3 offset:32384
    v_mfma_f32_16x16x32_bf16 v[44:47], v[208:211], v[68:71], v[44:47]
    ds_read_b64_tr_b16 v[180:181], v3 offset:28832
    v_mfma_f32_16x16x32_bf16 v[48:51], v[208:211], v[76:79], v[48:51]
    ds_read_b64_tr_b16 v[182:183], v3 offset:32416
    v_mfma_f32_16x16x32_bf16 v[52:55], v[212:215], v[68:71], v[52:55]
    ds_read_b64_tr_b16 v[184:185], v3 offset:28864
    v_mfma_f32_16x16x32_bf16 v[56:59], v[212:215], v[76:79], v[56:59]
    ds_read_b64_tr_b16 v[186:187], v3 offset:32448
    s_waitcnt lgkmcnt(0)
    v_mfma_f32_16x16x32_bf16 v[4:7], v[160:163], v[80:83], v[4:7]
    ds_read_b64_tr_b16 v[188:189], v248 offset:3072
    v_mfma_f32_16x16x32_bf16 v[8:11], v[160:163], v[88:91], v[8:11]
    ds_read_b64_tr_b16 v[190:191], v248 offset:6656
    v_mfma_f32_16x16x32_bf16 v[12:15], v[164:167], v[80:83], v[12:15]
    ds_read_b64_tr_b16 v[192:193], v248 offset:3104
    v_mfma_f32_16x16x32_bf16 v[16:19], v[164:167], v[88:91], v[16:19]
    ds_read_b64_tr_b16 v[194:195], v248 offset:6688
    v_mfma_f32_16x16x32_bf16 v[20:23], v[168:171], v[80:83], v[20:23]
    ds_read_b64_tr_b16 v[196:197], v248 offset:3136
    v_mfma_f32_16x16x32_bf16 v[24:27], v[168:171], v[88:91], v[24:27]
    ds_read_b64_tr_b16 v[198:199], v248 offset:6720
    v_mfma_f32_16x16x32_bf16 v[28:31], v[172:175], v[80:83], v[28:31]
    ds_read_b64_tr_b16 v[200:201], v248 offset:3168
    v_mfma_f32_16x16x32_bf16 v[32:35], v[172:175], v[88:91], v[32:35]
    ds_read_b64_tr_b16 v[202:203], v248 offset:6752
    v_mfma_f32_16x16x32_bf16 v[36:39], v[176:179], v[80:83], v[36:39]
    ds_read_b64_tr_b16 v[204:205], v248 offset:3200
    v_mfma_f32_16x16x32_bf16 v[40:43], v[176:179], v[88:91], v[40:43]
    ds_read_b64_tr_b16 v[206:207], v248 offset:6784
    v_mfma_f32_16x16x32_bf16 v[44:47], v[180:183], v[80:83], v[44:47]
    ds_read_b64_tr_b16 v[208:209], v248 offset:3232
    v_mfma_f32_16x16x32_bf16 v[48:51], v[180:183], v[88:91], v[48:51]
    ds_read_b64_tr_b16 v[210:211], v248 offset:6816
    v_mfma_f32_16x16x32_bf16 v[52:55], v[184:187], v[80:83], v[52:55]
    ds_read_b64_tr_b16 v[212:213], v248 offset:3264
    v_mfma_f32_16x16x32_bf16 v[56:59], v[184:187], v[88:91], v[56:59]
    ds_read_b64_tr_b16 v[214:215], v248 offset:6848
    s_waitcnt lgkmcnt(0)
    v_mfma_f32_16x16x32_bf16 v[4:7], v[188:191], v[84:87], v[4:7]
    v_mfma_f32_16x16x32_bf16 v[8:11], v[188:191], v[92:95], v[8:11]
    v_mfma_f32_16x16x32_bf16 v[12:15], v[192:195], v[84:87], v[12:15]
    v_mfma_f32_16x16x32_bf16 v[16:19], v[192:195], v[92:95], v[16:19]
    v_mfma_f32_16x16x32_bf16 v[20:23], v[196:199], v[84:87], v[20:23]
    v_mfma_f32_16x16x32_bf16 v[24:27], v[196:199], v[92:95], v[24:27]
    v_mfma_f32_16x16x32_bf16 v[28:31], v[200:203], v[84:87], v[28:31]
    v_mfma_f32_16x16x32_bf16 v[32:35], v[200:203], v[92:95], v[32:35]
    v_mfma_f32_16x16x32_bf16 v[36:39], v[204:207], v[84:87], v[36:39]
    v_mfma_f32_16x16x32_bf16 v[40:43], v[204:207], v[92:95], v[40:43]
    v_mfma_f32_16x16x32_bf16 v[44:47], v[208:211], v[84:87], v[44:47]
    v_mfma_f32_16x16x32_bf16 v[48:51], v[208:211], v[92:95], v[48:51]
    v_mfma_f32_16x16x32_bf16 v[52:55], v[212:215], v[84:87], v[52:55]
    v_mfma_f32_16x16x32_bf16 v[56:59], v[212:215], v[92:95], v[56:59]
    s_add_u32 s36, s32, 0x400000
    s_addc_u32 s37, s33, 0
    s_mov_b32 s38, 0x1c0000
    s_mov_b32 s39, 0x00020000
    s_add_u32 s40, s32, 0x600000
    s_addc_u32 s41, s33, 0
    s_mov_b32 s42, 0x700000
    s_mov_b32 s43, 0x00020000
    s_add_u32 s44, s32, 0xd80000
    s_addc_u32 s45, s33, 0
    s_mov_b32 s46, 0x200000
    s_mov_b32 s47, 0x00020000
    s_mov_b32 s48, s28
    s_mov_b32 s49, s29
    s_mov_b32 s50, 0x200000
    s_mov_b32 s51, 0x00020000
    v_lshlrev_b32 v244, 3, v1
    v_lshlrev_b32 v245, 2, v1
    s_lshl_b32 s70, s66, 4
    s_lshl_b32 s71, s60, 2
    s_add_u32 s70, s70, s71
    s_mul_i32 s68, s70, 14336
    s_lshl_b32 s70, s65, 4
    s_add_u32 s70, s70, s71
    s_mul_i32 s69, s70, 14336
    s_lshl_b32 s77, s66, 7
    s_add_u32 s77, s77, 4096
    buffer_load_dword v228, v245, s[52:55], s77 offen sc1
    s_mov_b32 s74, 0xbdd2d3e8
    s_mov_b32 s75, 0xbdd2d3e8
    v_mov_b32 v246, 0xc0135761
    v_mov_b32 v247, 0xc0135761
    s_lshr_b32 s70, s67, 2
    s_lshl_b32 s70, s70, 4
    s_add_u32 s70, s70, s64
    s_mul_i32 s70, s70, 14336
    s_and_b32 s71, s67, 3
    s_lshl_b32 s73, s71, 9
    s_add_u32 s73, s73, s70
    s_add_u32 s73, s73, 12288
    s_lshl_b32 s71, s71, 10
    s_add_u32 s70, s70, s71
    v_pk_mul_f32 v[164:165], v[4:5], v[4:5]
    v_pk_mul_f32 v[166:167], v[6:7], v[6:7]
    v_pk_mul_f32 v[168:169], v[12:13], v[12:13]
    v_pk_mul_f32 v[170:171], v[14:15], v[14:15]
    v_pk_fma_f32 v[164:165], v[164:165], s[74:75], v[246:247]
    v_pk_fma_f32 v[166:167], v[166:167], s[74:75], v[246:247]
    v_pk_fma_f32 v[168:169], v[168:169], s[74:75], v[246:247]
    v_pk_fma_f32 v[170:171], v[170:171], s[74:75], v[246:247]
    v_pk_mul_f32 v[164:165], v[4:5], v[164:165]
    v_pk_mul_f32 v[166:167], v[6:7], v[166:167]
    v_pk_mul_f32 v[168:169], v[12:13], v[168:169]
    v_pk_mul_f32 v[170:171], v[14:15], v[170:171]
    v_exp_f32 v164, v164
    v_exp_f32 v165, v165
    v_exp_f32 v166, v166
    v_exp_f32 v167, v167
    v_exp_f32 v168, v168
    v_exp_f32 v169, v169
    v_exp_f32 v170, v170
    v_exp_f32 v171, v171
    s_nop 0
    v_pk_add_f32 v[164:165], v[164:165], 1.0 op_sel_hi:[1,0]
    v_pk_add_f32 v[166:167], v[166:167], 1.0 op_sel_hi:[1,0]
    v_pk_add_f32 v[168:169], v[168:169], 1.0 op_sel_hi:[1,0]
    v_pk_add_f32 v[170:171], v[170:171], 1.0 op_sel_hi:[1,0]
    v_rcp_f32 v164, v164
    v_rcp_f32 v165, v165
    v_rcp_f32 v166, v166
    v_rcp_f32 v167, v167
    v_rcp_f32 v168, v168
    v_rcp_f32 v169, v169
    v_rcp_f32 v170, v170
    v_rcp_f32 v171, v171
    s_nop 0
    v_pk_mul_f32 v[164:165], v[4:5], v[164:165]
    v_pk_mul_f32 v[166:167], v[6:7], v[166:167]
    v_pk_mul_f32 v[168:169], v[12:13], v[168:169]
    v_pk_mul_f32 v[170:171], v[14:15], v[170:171]
    v_cvt_pk_bf16_f32 v176, v164, v165
    v_cvt_pk_bf16_f32 v177, v166, v167
    v_cvt_pk_bf16_f32 v178, v168, v169
    v_cvt_pk_bf16_f32 v179, v170, v171
    buffer_store_dwordx4 v[176:179], v2, s[40:43], s70 offen offset:0 sc1
    v_pk_mul_f32 v[164:165], v[8:9], v[8:9]
    v_pk_mul_f32 v[166:167], v[10:11], v[10:11]
    v_pk_mul_f32 v[168:169], v[16:17], v[16:17]
    v_pk_mul_f32 v[170:171], v[18:19], v[18:19]
    v_pk_fma_f32 v[164:165], v[164:165], s[74:75], v[246:247]
    v_pk_fma_f32 v[166:167], v[166:167], s[74:75], v[246:247]
    v_pk_fma_f32 v[168:169], v[168:169], s[74:75], v[246:247]
    v_pk_fma_f32 v[170:171], v[170:171], s[74:75], v[246:247]
    v_pk_mul_f32 v[164:165], v[8:9], v[164:165]
    v_pk_mul_f32 v[166:167], v[10:11], v[166:167]
    v_pk_mul_f32 v[168:169], v[16:17], v[168:169]
    v_pk_mul_f32 v[170:171], v[18:19], v[170:171]
    v_exp_f32 v164, v164
    v_exp_f32 v165, v165
    v_exp_f32 v166, v166
    v_exp_f32 v167, v167
    v_exp_f32 v168, v168
    v_exp_f32 v169, v169
    v_exp_f32 v170, v170
    v_exp_f32 v171, v171
    s_nop 0
    v_pk_add_f32 v[164:165], v[164:165], 1.0 op_sel_hi:[1,0]
    v_pk_add_f32 v[166:167], v[166:167], 1.0 op_sel_hi:[1,0]
    v_pk_add_f32 v[168:169], v[168:169], 1.0 op_sel_hi:[1,0]
    v_pk_add_f32 v[170:171], v[170:171], 1.0 op_sel_hi:[1,0]
    v_rcp_f32 v164, v164
    v_rcp_f32 v165, v165
    v_rcp_f32 v166, v166
    v_rcp_f32 v167, v167
    v_rcp_f32 v168, v168
    v_rcp_f32 v169, v169
    v_rcp_f32 v170, v170
    v_rcp_f32 v171, v171
    s_nop 0
    v_pk_mul_f32 v[164:165], v[8:9], v[164:165]
    v_pk_mul_f32 v[166:167], v[10:11], v[166:167]
    v_pk_mul_f32 v[168:169], v[16:17], v[168:169]
    v_pk_mul_f32 v[170:171], v[18:19], v[170:171]
    v_cvt_pk_bf16_f32 v180, v164, v165
    v_cvt_pk_bf16_f32 v181, v166, v167
    v_cvt_pk_bf16_f32 v182, v168, v169
    v_cvt_pk_bf16_f32 v183, v170, v171
    buffer_store_dwordx4 v[180:183], v2, s[40:43], s70 offen offset:1024 sc1
    s_add_u32 s70, s70, 4096
    v_pk_mul_f32 v[164:165], v[20:21], v[20:21]
    v_pk_mul_f32 v[166:167], v[22:23], v[22:23]
    v_pk_mul_f32 v[168:169], v[28:29], v[28:29]
    v_pk_mul_f32 v[170:171], v[30:31], v[30:31]
    v_pk_fma_f32 v[164:165], v[164:165], s[74:75], v[246:247]
    v_pk_fma_f32 v[166:167], v[166:167], s[74:75], v[246:247]
    v_pk_fma_f32 v[168:169], v[168:169], s[74:75], v[246:247]
    v_pk_fma_f32 v[170:171], v[170:171], s[74:75], v[246:247]
    v_pk_mul_f32 v[164:165], v[20:21], v[164:165]
    v_pk_mul_f32 v[166:167], v[22:23], v[166:167]
    v_pk_mul_f32 v[168:169], v[28:29], v[168:169]
    v_pk_mul_f32 v[170:171], v[30:31], v[170:171]
    v_exp_f32 v164, v164
    v_exp_f32 v165, v165
    v_exp_f32 v166, v166
    v_exp_f32 v167, v167
    v_exp_f32 v168, v168
    v_exp_f32 v169, v169
    v_exp_f32 v170, v170
    v_exp_f32 v171, v171
    s_nop 0
    v_pk_add_f32 v[164:165], v[164:165], 1.0 op_sel_hi:[1,0]
    v_pk_add_f32 v[166:167], v[166:167], 1.0 op_sel_hi:[1,0]
    v_pk_add_f32 v[168:169], v[168:169], 1.0 op_sel_hi:[1,0]
    v_pk_add_f32 v[170:171], v[170:171], 1.0 op_sel_hi:[1,0]
    v_rcp_f32 v164, v164
    v_rcp_f32 v165, v165
    v_rcp_f32 v166, v166
    v_rcp_f32 v167, v167
    v_rcp_f32 v168, v168
    v_rcp_f32 v169, v169
    v_rcp_f32 v170, v170
    v_rcp_f32 v171, v171
    s_nop 0
    v_pk_mul_f32 v[164:165], v[20:21], v[164:165]
    v_pk_mul_f32 v[166:167], v[22:23], v[166:167]
    v_pk_mul_f32 v[168:169], v[28:29], v[168:169]
    v_pk_mul_f32 v[170:171], v[30:31], v[170:171]
    v_cvt_pk_bf16_f32 v184, v164, v165
    v_cvt_pk_bf16_f32 v185, v166, v167
    v_cvt_pk_bf16_f32 v186, v168, v169
    v_cvt_pk_bf16_f32 v187, v170, v171
    buffer_store_dwordx4 v[184:187], v2, s[40:43], s70 offen offset:0 sc1
    v_pk_mul_f32 v[164:165], v[24:25], v[24:25]
    v_pk_mul_f32 v[166:167], v[26:27], v[26:27]
    v_pk_mul_f32 v[168:169], v[32:33], v[32:33]
    v_pk_mul_f32 v[170:171], v[34:35], v[34:35]
    v_pk_fma_f32 v[164:165], v[164:165], s[74:75], v[246:247]
    v_pk_fma_f32 v[166:167], v[166:167], s[74:75], v[246:247]
    v_pk_fma_f32 v[168:169], v[168:169], s[74:75], v[246:247]
    v_pk_fma_f32 v[170:171], v[170:171], s[74:75], v[246:247]
    v_pk_mul_f32 v[164:165], v[24:25], v[164:165]
    v_pk_mul_f32 v[166:167], v[26:27], v[166:167]
    v_pk_mul_f32 v[168:169], v[32:33], v[168:169]
    v_pk_mul_f32 v[170:171], v[34:35], v[170:171]
    v_exp_f32 v164, v164
    v_exp_f32 v165, v165
    v_exp_f32 v166, v166
    v_exp_f32 v167, v167
    v_exp_f32 v168, v168
    v_exp_f32 v169, v169
    v_exp_f32 v170, v170
    v_exp_f32 v171, v171
    s_nop 0
    v_pk_add_f32 v[164:165], v[164:165], 1.0 op_sel_hi:[1,0]
    v_pk_add_f32 v[166:167], v[166:167], 1.0 op_sel_hi:[1,0]
    v_pk_add_f32 v[168:169], v[168:169], 1.0 op_sel_hi:[1,0]
    v_pk_add_f32 v[170:171], v[170:171], 1.0 op_sel_hi:[1,0]
    v_rcp_f32 v164, v164
    v_rcp_f32 v165, v165
    v_rcp_f32 v166, v166
    v_rcp_f32 v167, v167
    v_rcp_f32 v168, v168
    v_rcp_f32 v169, v169
    v_rcp_f32 v170, v170
    v_rcp_f32 v171, v171
    s_nop 0
    v_pk_mul_f32 v[164:165], v[24:25], v[164:165]
    v_pk_mul_f32 v[166:167], v[26:27], v[166:167]
    v_pk_mul_f32 v[168:169], v[32:33], v[168:169]
    v_pk_mul_f32 v[170:171], v[34:35], v[170:171]
    v_cvt_pk_bf16_f32 v188, v164, v165
    v_cvt_pk_bf16_f32 v189, v166, v167
    v_cvt_pk_bf16_f32 v190, v168, v169
    v_cvt_pk_bf16_f32 v191, v170, v171
    buffer_store_dwordx4 v[188:191], v2, s[40:43], s70 offen offset:1024 sc1
    s_add_u32 s70, s70, 4096
    v_pk_mul_f32 v[164:165], v[36:37], v[36:37]
    v_pk_mul_f32 v[166:167], v[38:39], v[38:39]
    v_pk_mul_f32 v[168:169], v[44:45], v[44:45]
    v_pk_mul_f32 v[170:171], v[46:47], v[46:47]
    v_pk_fma_f32 v[164:165], v[164:165], s[74:75], v[246:247]
    v_pk_fma_f32 v[166:167], v[166:167], s[74:75], v[246:247]
    v_pk_fma_f32 v[168:169], v[168:169], s[74:75], v[246:247]
    v_pk_fma_f32 v[170:171], v[170:171], s[74:75], v[246:247]
    v_pk_mul_f32 v[164:165], v[36:37], v[164:165]
    v_pk_mul_f32 v[166:167], v[38:39], v[166:167]
    v_pk_mul_f32 v[168:169], v[44:45], v[168:169]
    v_pk_mul_f32 v[170:171], v[46:47], v[170:171]
    v_exp_f32 v164, v164
    v_exp_f32 v165, v165
    v_exp_f32 v166, v166
    v_exp_f32 v167, v167
    v_exp_f32 v168, v168
    v_exp_f32 v169, v169
    v_exp_f32 v170, v170
    v_exp_f32 v171, v171
    s_nop 0
    v_pk_add_f32 v[164:165], v[164:165], 1.0 op_sel_hi:[1,0]
    v_pk_add_f32 v[166:167], v[166:167], 1.0 op_sel_hi:[1,0]
    v_pk_add_f32 v[168:169], v[168:169], 1.0 op_sel_hi:[1,0]
    v_pk_add_f32 v[170:171], v[170:171], 1.0 op_sel_hi:[1,0]
    v_rcp_f32 v164, v164
    v_rcp_f32 v165, v165
    v_rcp_f32 v166, v166
    v_rcp_f32 v167, v167
    v_rcp_f32 v168, v168
    v_rcp_f32 v169, v169
    v_rcp_f32 v170, v170
    v_rcp_f32 v171, v171
    s_nop 0
    v_pk_mul_f32 v[164:165], v[36:37], v[164:165]
    v_pk_mul_f32 v[166:167], v[38:39], v[166:167]
    v_pk_mul_f32 v[168:169], v[44:45], v[168:169]
    v_pk_mul_f32 v[170:171], v[46:47], v[170:171]
    v_cvt_pk_bf16_f32 v192, v164, v165
    v_cvt_pk_bf16_f32 v193, v166, v167
    v_cvt_pk_bf16_f32 v194, v168, v169
    v_cvt_pk_bf16_f32 v195, v170, v171
    buffer_store_dwordx4 v[192:195], v2, s[40:43], s70 offen offset:0 sc1
    v_pk_mul_f32 v[164:165], v[40:41], v[40:41]
    v_pk_mul_f32 v[166:167], v[42:43], v[42:43]
    v_pk_mul_f32 v[168:169], v[48:49], v[48:49]
    v_pk_mul_f32 v[170:171], v[50:51], v[50:51]
    v_pk_fma_f32 v[164:165], v[164:165], s[74:75], v[246:247]
    v_pk_fma_f32 v[166:167], v[166:167], s[74:75], v[246:247]
    v_pk_fma_f32 v[168:169], v[168:169], s[74:75], v[246:247]
    v_pk_fma_f32 v[170:171], v[170:171], s[74:75], v[246:247]
    v_pk_mul_f32 v[164:165], v[40:41], v[164:165]
    v_pk_mul_f32 v[166:167], v[42:43], v[166:167]
    v_pk_mul_f32 v[168:169], v[48:49], v[168:169]
    v_pk_mul_f32 v[170:171], v[50:51], v[170:171]
    v_exp_f32 v164, v164
    v_exp_f32 v165, v165
    v_exp_f32 v166, v166
    v_exp_f32 v167, v167
    v_exp_f32 v168, v168
    v_exp_f32 v169, v169
    v_exp_f32 v170, v170
    v_exp_f32 v171, v171
    s_nop 0
    v_pk_add_f32 v[164:165], v[164:165], 1.0 op_sel_hi:[1,0]
    v_pk_add_f32 v[166:167], v[166:167], 1.0 op_sel_hi:[1,0]
    v_pk_add_f32 v[168:169], v[168:169], 1.0 op_sel_hi:[1,0]
    v_pk_add_f32 v[170:171], v[170:171], 1.0 op_sel_hi:[1,0]
    v_rcp_f32 v164, v164
    v_rcp_f32 v165, v165
    v_rcp_f32 v166, v166
    v_rcp_f32 v167, v167
    v_rcp_f32 v168, v168
    v_rcp_f32 v169, v169
    v_rcp_f32 v170, v170
    v_rcp_f32 v171, v171
    s_nop 0
    v_pk_mul_f32 v[164:165], v[40:41], v[164:165]
    v_pk_mul_f32 v[166:167], v[42:43], v[166:167]
    v_pk_mul_f32 v[168:169], v[48:49], v[168:169]
    v_pk_mul_f32 v[170:171], v[50:51], v[170:171]
    v_cvt_pk_bf16_f32 v196, v164, v165
    v_cvt_pk_bf16_f32 v197, v166, v167
    v_cvt_pk_bf16_f32 v198, v168, v169
    v_cvt_pk_bf16_f32 v199, v170, v171
    buffer_store_dwordx4 v[196:199], v2, s[40:43], s70 offen offset:1024 sc1
    v_pk_mul_f32 v[164:165], v[52:53], v[52:53]
    v_pk_mul_f32 v[166:167], v[54:55], v[54:55]
    v_pk_mul_f32 v[168:169], v[56:57], v[56:57]
    v_pk_mul_f32 v[170:171], v[58:59], v[58:59]
    v_pk_fma_f32 v[164:165], v[164:165], s[74:75], v[246:247]
    v_pk_fma_f32 v[166:167], v[166:167], s[74:75], v[246:247]
    v_pk_fma_f32 v[168:169], v[168:169], s[74:75], v[246:247]
    v_pk_fma_f32 v[170:171], v[170:171], s[74:75], v[246:247]
    v_pk_mul_f32 v[164:165], v[52:53], v[164:165]
    v_pk_mul_f32 v[166:167], v[54:55], v[166:167]
    v_pk_mul_f32 v[168:169], v[56:57], v[168:169]
    v_pk_mul_f32 v[170:171], v[58:59], v[170:171]
    v_exp_f32 v164, v164
    v_exp_f32 v165, v165
    v_exp_f32 v166, v166
    v_exp_f32 v167, v167
    v_exp_f32 v168, v168
    v_exp_f32 v169, v169
    v_exp_f32 v170, v170
    v_exp_f32 v171, v171
    s_nop 0
    v_pk_add_f32 v[164:165], v[164:165], 1.0 op_sel_hi:[1,0]
    v_pk_add_f32 v[166:167], v[166:167], 1.0 op_sel_hi:[1,0]
    v_pk_add_f32 v[168:169], v[168:169], 1.0 op_sel_hi:[1,0]
    v_pk_add_f32 v[170:171], v[170:171], 1.0 op_sel_hi:[1,0]
    v_rcp_f32 v164, v164
    v_rcp_f32 v165, v165
    v_rcp_f32 v166, v166
    v_rcp_f32 v167, v167
    v_rcp_f32 v168, v168
    v_rcp_f32 v169, v169
    v_rcp_f32 v170, v170
    v_rcp_f32 v171, v171
    s_nop 0
    v_pk_mul_f32 v[164:165], v[52:53], v[164:165]
    v_pk_mul_f32 v[166:167], v[54:55], v[166:167]
    v_pk_mul_f32 v[168:169], v[56:57], v[168:169]
    v_pk_mul_f32 v[170:171], v[58:59], v[170:171]
    v_cvt_pk_bf16_f32 v200, v164, v165
    v_cvt_pk_bf16_f32 v201, v166, v167
    v_cvt_pk_bf16_f32 v202, v168, v169
    v_cvt_pk_bf16_f32 v203, v170, v171
    buffer_store_dwordx2 v[200:201], v244, s[40:43], s73 offen sc1
    buffer_store_dwordx2 v[202:203], v244, s[40:43], s73 offen offset:512 sc1
    s_waitcnt vmcnt(0)
    s_barrier
    s_cmp_eq_u32 s60, 0
    s_cbranch_scc0 FG_HF
    s_lshl_b32 s70, s63, 4
    s_add_u32 s70, s70, s64
    s_lshl_b32 s70, s70, 7
    s_add_u32 s70, s70, 16384
    v_mov_b32 v230, 0
    v_mov_b32 v231, s34
    s_mov_b64 exec, 1
    buffer_store_dword v231, v230, s[52:55], s70 offen sc1
    s_lshl_b32 s70, s63, 5
    s_add_u32 s70, s70, s64
    s_lshl_b32 s70, s70, 2
    s_add_u32 s70, s70, 1024
    buffer_store_dword v231, v230, s[52:55], s70 offen sc1
    s_mov_b64 exec, -1
FG_HF:
    v_cmp_ne_u32 vcc, s34, v228
    s_cmp_eq_u32 vcc_lo, 0
    s_cbranch_scc1 FG_RFOK
    s_mov_b32 s70, s77
    s_mov_b32 s76, 1048576
    s_mov_b32 s74, 0xffffffff
    s_mov_b32 s75, 0
POLL_FG_2:
    buffer_load_dword v230, v245, s[52:55], s70 offen offset:0 sc1
    s_waitcnt vmcnt(0)
    v_xor_b32 v230, s34, v230
    v_cmp_ne_u32 vcc, 0, v230
    s_and_b64 vcc, vcc, s[74:75]
    s_cbranch_scc0 POLL_FG_2_D
    s_sleep 4
    s_sub_u32 s76, s76, 1
    s_cmp_lg_u32 s76, 0
    s_cbranch_scc1 POLL_FG_2
POLL_FG_2_D:
FG_RFOK:
    s_lshl_b32 s35, s60, 14
    v_add_u32 v246, s35, v2
    v_add_u32 v247, s35, v244
    s_lshr_b32 s3, s65, 1
    s_lshl_b32 s3, s3, 11
    s_lshl_b32 s70, s60, 9
    s_add_u32 s3, s3, s70
    s_add_u32 s3, s3, 16384
    v_and_b32 v248, 3, v1
    v_lshlrev_b32 v248, 7, v248
    s_mov_b32 s61, 0
    s_add_u32 s70, s68, 0
    buffer_load_dwordx4 v[68:71], v2, s[36:39], s70 offen offset:0
    buffer_load_dwordx4 v[72:75], v2, s[36:39], s70 offen offset:1024
    buffer_load_dwordx4 v[76:79], v2, s[36:39], s70 offen offset:2048
    buffer_load_dwordx4 v[80:83], v2, s[36:39], s70 offen offset:3072
    s_add_u32 s70, s68, 4096
    buffer_load_dwordx4 v[84:87], v2, s[36:39], s70 offen offset:0
    buffer_load_dwordx4 v[88:91], v2, s[36:39], s70 offen offset:1024
    buffer_load_dwordx4 v[92:95], v2, s[36:39], s70 offen offset:2048
    buffer_load_dwordx4 v[96:99], v2, s[36:39], s70 offen offset:3072
    s_add_u32 s70, s68, 8192
    buffer_load_dwordx4 v[100:103], v2, s[36:39], s70 offen offset:0
    buffer_load_dwordx4 v[104:107], v2, s[36:39], s70 offen offset:1024
    buffer_load_dwordx4 v[108:111], v2, s[36:39], s70 offen offset:2048
    buffer_load_dwordx4 v[112:115], v2, s[36:39], s70 offen offset:3072
    buffer_load_dword v228, v248, s[52:55], s3 offen sc1
    s_add_u32 s70, s68, 12288
    buffer_load_dwordx2 v[116:117], v244, s[36:39], s70 offen offset:0
    buffer_load_dwordx2 v[120:121], v244, s[36:39], s70 offen offset:512
    buffer_load_dwordx2 v[124:125], v244, s[36:39], s70 offen offset:1024
    buffer_load_dwordx2 v[128:129], v244, s[36:39], s70 offen offset:1536
    s_add_u32 s70, s68, 14336
    buffer_load_dwordx4 v[132:135], v2, s[36:39], s70 offen offset:0
    buffer_load_dwordx4 v[136:139], v2, s[36:39], s70 offen offset:1024
    buffer_load_dwordx4 v[140:143], v2, s[36:39], s70 offen offset:2048
    buffer_load_dwordx4 v[144:147], v2, s[36:39], s70 offen offset:3072
    s_add_u32 s70, s68, 18432
    buffer_load_dwordx4 v[148:151], v2, s[36:39], s70 offen offset:0
    buffer_load_dwordx4 v[152:155], v2, s[36:39], s70 offen offset:1024
    buffer_load_dwordx4 v[156:159], v2, s[36:39], s70 offen offset:2048
    buffer_load_dwordx4 v[160:163], v2, s[36:39], s70 offen offset:3072
    v_mov_b32 v4, 0
    v_mov_b32 v5, 0
    v_mov_b32 v6, 0
    v_mov_b32 v7, 0
    v_mov_b32 v8, 0
    v_mov_b32 v9, 0
    v_mov_b32 v10, 0
    v_mov_b32 v11, 0
    v_mov_b32 v12, 0
    v_mov_b32 v13, 0
    v_mov_b32 v14, 0
    v_mov_b32 v15, 0
    v_mov_b32 v16, 0
    v_mov_b32 v17, 0
    v_mov_b32 v18, 0
    v_mov_b32 v19, 0
    v_mov_b32 v20, 0
    v_mov_b32 v21, 0
    v_mov_b32 v22, 0
    v_mov_b32 v23, 0
    v_mov_b32 v24, 0
    v_mov_b32 v25, 0
    v_mov_b32 v26, 0
    v_mov_b32 v27, 0
    v_mov_b32 v28, 0
    v_mov_b32 v29, 0
    v_mov_b32 v30, 0
    v_mov_b32 v31, 0
    v_mov_b32 v32, 0
    v_mov_b32 v33, 0
    v_mov_b32 v34, 0
    v_mov_b32 v35, 0
    v_mov_b32 v36, 0
    v_mov_b32 v37, 0
    v_mov_b32 v38, 0
    v_mov_b32 v39, 0
    v_mov_b32 v40, 0
    v_mov_b32 v41, 0
    v_mov_b32 v42, 0
    v_mov_b32 v43, 0
    v_mov_b32 v44, 0
    v_mov_b32 v45, 0
    v_mov_b32 v46, 0
    v_mov_b32 v47, 0
    v_mov_b32 v48, 0
    v_mov_b32 v49, 0
    v_mov_b32 v50, 0
    v_mov_b32 v51, 0
    v_mov_b32 v52, 0
    v_mov_b32 v53, 0
    v_mov_b32 v54, 0
    v_mov_b32 v55, 0
    v_mov_b32 v56, 0
    v_mov_b32 v57, 0
    v_mov_b32 v58, 0
    v_mov_b32 v59, 0
    v_mov_b32 v60, 0
    v_mov_b32 v61, 0
    v_mov_b32 v62, 0
    v_mov_b32 v63, 0
    v_mov_b32 v64, 0
    v_mov_b32 v65, 0
    v_mov_b32 v66, 0
    v_mov_b32 v67, 0
    s_waitcnt vmcnt(12)
    v_cmp_eq_u32 vcc, s34, v228
    s_and_b32 s61, vcc_lo, 15
    s_bitcmp1_b32 s61, 0
    s_cbranch_scc1 FG_HW3_D
    s_mov_b32 s76, 1048576
FG_HW3:
    buffer_load_dword v230, v248, s[52:55], s3 offen sc1
    s_waitcnt vmcnt(0)
    v_cmp_eq_u32 vcc, s34, v230
    s_and_b32 s61, vcc_lo, 15
    s_bitcmp1_b32 s61, 0
    s_cbranch_scc1 FG_HW3_D
    s_sleep 2
    s_sub_u32 s76, s76, 1
    s_cmp_lg_u32 s76, 0
    s_cbranch_scc1 FG_HW3
FG_HW3_D:
    s_add_u32 s70, s69, 0
    buffer_load_dwordx4 v[164:167], v2, s[40:43], s70 offen offset:0
    buffer_load_dwordx4 v[168:171], v2, s[40:43], s70 offen offset:1024
    buffer_load_dwordx4 v[172:175], v2, s[40:43], s70 offen offset:2048
    buffer_load_dwordx4 v[176:179], v2, s[40:43], s70 offen offset:3072
    s_add_u32 s70, s69, 4096
    buffer_load_dwordx4 v[180:183], v2, s[40:43], s70 offen offset:0
    buffer_load_dwordx4 v[184:187], v2, s[40:43], s70 offen offset:1024
    buffer_load_dwordx4 v[188:191], v2, s[40:43], s70 offen offset:2048
    buffer_load_dwordx4 v[192:195], v2, s[40:43], s70 offen offset:3072
    s_add_u32 s70, s69, 8192
    buffer_load_dwordx4 v[196:199], v2, s[40:43], s70 offen offset:0
    buffer_load_dwordx4 v[200:203], v2, s[40:43], s70 offen offset:1024
    buffer_load_dwordx4 v[204:207], v2, s[40:43], s70 offen offset:2048
    buffer_load_dwordx4 v[208:211], v2, s[40:43], s70 offen offset:3072
    s_add_u32 s70, s69, 12288
    buffer_load_dwordx2 v[212:213], v244, s[40:43], s70 offen offset:0
    buffer_load_dwordx2 v[216:217], v244, s[40:43], s70 offen offset:512
    buffer_load_dwordx2 v[220:221], v244, s[40:43], s70 offen offset:1024
    buffer_load_dwordx2 v[224:225], v244, s[40:43], s70 offen offset:1536
    s_add_u32 s70, s68, 22528
    s_add_u32 s71, s35, 0
    s_mov_b32 m0, s71
    s_nop 0
    buffer_load_dwordx4 v2, s[36:39], s70 offen offset:0 lds
    buffer_load_dwordx4 v2, s[36:39], s70 offen offset:1024 lds
    buffer_load_dwordx4 v2, s[36:39], s70 offen offset:2048 lds
    buffer_load_dwordx4 v2, s[36:39], s70 offen offset:3072 lds
    s_add_u32 s70, s68, 26624
    s_add_u32 s71, s35, 4096
    s_mov_b32 m0, s71
    s_nop 0
    buffer_load_dwordx4 v2, s[36:39], s70 offen offset:0 lds
    buffer_load_dwordx4 v2, s[36:39], s70 offen offset:1024 lds
    s_add_u32 s70, s68, 28672
    s_add_u32 s71, s35, 8192
    s_mov_b32 m0, s71
    s_nop 0
    buffer_load_dwordx4 v2, s[36:39], s70 offen offset:0 lds
    buffer_load_dwordx4 v2, s[36:39], s70 offen offset:1024 lds
    buffer_load_dwordx4 v2, s[36:39], s70 offen offset:2048 lds
    buffer_load_dwordx4 v2, s[36:39], s70 offen offset:3072 lds
    s_add_u32 s70, s68, 32768
    s_add_u32 s71, s35, 12288
    s_mov_b32 m0, s71
    s_nop 0
    buffer_load_dwordx4 v2, s[36:39], s70 offen offset:0 lds
    buffer_load_dwordx4 v2, s[36:39], s70 offen offset:1024 lds
    buffer_load_dwordx4 v2, s[36:39], s70 offen offset:2048 lds
    buffer_load_dwordx4 v2, s[36:39], s70 offen offset:3072 lds
    s_waitcnt vmcnt(26)
    v_mfma_f32_16x16x32_bf16 v[4:7], v[68:71], v[164:167], v[4:7]
    v_mfma_f32_16x16x32_bf16 v[20:23], v[68:71], v[168:171], v[20:23]
    v_mfma_f32_16x16x32_bf16 v[36:39], v[68:71], v[172:175], v[36:39]
    v_mfma_f32_16x16x32_bf16 v[52:55], v[68:71], v[176:179], v[52:55]
    v_mfma_f32_16x16x32_bf16 v[8:11], v[72:75], v[164:167], v[8:11]
    v_mfma_f32_16x16x32_bf16 v[24:27], v[72:75], v[168:171], v[24:27]
    v_mfma_f32_16x16x32_bf16 v[40:43], v[72:75], v[172:175], v[40:43]
    v_mfma_f32_16x16x32_bf16 v[56:59], v[72:75], v[176:179], v[56:59]
    v_mfma_f32_16x16x32_bf16 v[12:15], v[76:79], v[164:167], v[12:15]
    v_mfma_f32_16x16x32_bf16 v[28:31], v[76:79], v[168:171], v[28:31]
    v_mfma_f32_16x16x32_bf16 v[44:47], v[76:79], v[172:175], v[44:47]
    v_mfma_f32_16x16x32_bf16 v[60:63], v[76:79], v[176:179], v[60:63]
    v_mfma_f32_16x16x32_bf16 v[16:19], v[80:83], v[164:167], v[16:19]
    v_mfma_f32_16x16x32_bf16 v[32:35], v[80:83], v[168:171], v[32:35]
    v_mfma_f32_16x16x32_bf16 v[48:51], v[80:83], v[172:175], v[48:51]
    v_mfma_f32_16x16x32_bf16 v[64:67], v[80:83], v[176:179], v[64:67]
    s_bitcmp1_b32 s61, 1
    s_cbranch_scc1 FG_HW4_D
    s_mov_b32 s76, 1048576
FG_HW4:
    buffer_load_dword v230, v248, s[52:55], s3 offen sc1
    s_waitcnt vmcnt(0)
    v_cmp_eq_u32 vcc, s34, v230
    s_and_b32 s61, vcc_lo, 15
    s_bitcmp1_b32 s61, 1
    s_cbranch_scc1 FG_HW4_D
    s_sleep 2
    s_sub_u32 s76, s76, 1
    s_cmp_lg_u32 s76, 0
    s_cbranch_scc1 FG_HW4
FG_HW4_D:
    s_add_u32 s70, s69, 14336
    buffer_load_dwordx4 v[164:167], v2, s[40:43], s70 offen offset:0
    buffer_load_dwordx4 v[168:171], v2, s[40:43], s70 offen offset:1024
    buffer_load_dwordx4 v[172:175], v2, s[40:43], s70 offen offset:2048
    buffer_load_dwordx4 v[176:179], v2, s[40:43], s70 offen offset:3072
    s_waitcnt vmcnt(26)
    v_mfma_f32_16x16x32_bf16 v[4:7], v[84:87], v[180:183], v[4:7]
    v_mfma_f32_16x16x32_bf16 v[20:23], v[84:87], v[184:187], v[20:23]
    v_mfma_f32_16x16x32_bf16 v[36:39], v[84:87], v[188:191], v[36:39]
    v_mfma_f32_16x16x32_bf16 v[52:55], v[84:87], v[192:195], v[52:55]
    v_mfma_f32_16x16x32_bf16 v[8:11], v[88:91], v[180:183], v[8:11]
    v_mfma_f32_16x16x32_bf16 v[24:27], v[88:91], v[184:187], v[24:27]
    v_mfma_f32_16x16x32_bf16 v[40:43], v[88:91], v[188:191], v[40:43]
    v_mfma_f32_16x16x32_bf16 v[56:59], v[88:91], v[192:195], v[56:59]
    v_mfma_f32_16x16x32_bf16 v[12:15], v[92:95], v[180:183], v[12:15]
    v_mfma_f32_16x16x32_bf16 v[28:31], v[92:95], v[184:187], v[28:31]
    v_mfma_f32_16x16x32_bf16 v[44:47], v[92:95], v[188:191], v[44:47]
    v_mfma_f32_16x16x32_bf16 v[60:63], v[92:95], v[192:195], v[60:63]
    v_mfma_f32_16x16x32_bf16 v[16:19], v[96:99], v[180:183], v[16:19]
    v_mfma_f32_16x16x32_bf16 v[32:35], v[96:99], v[184:187], v[32:35]
    v_mfma_f32_16x16x32_bf16 v[48:51], v[96:99], v[188:191], v[48:51]
    v_mfma_f32_16x16x32_bf16 v[64:67], v[96:99], v[192:195], v[64:67]
    s_add_u32 s70, s69, 18432
    buffer_load_dwordx4 v[180:183], v2, s[40:43], s70 offen offset:0
    buffer_load_dwordx4 v[184:187], v2, s[40:43], s70 offen offset:1024
    buffer_load_dwordx4 v[188:191], v2, s[40:43], s70 offen offset:2048
    buffer_load_dwordx4 v[192:195], v2, s[40:43], s70 offen offset:3072
    s_waitcnt vmcnt(26)
    v_mfma_f32_16x16x32_bf16 v[4:7], v[100:103], v[196:199], v[4:7]
    v_mfma_f32_16x16x32_bf16 v[20:23], v[100:103], v[200:203], v[20:23]
    v_mfma_f32_16x16x32_bf16 v[36:39], v[100:103], v[204:207], v[36:39]
    v_mfma_f32_16x16x32_bf16 v[52:55], v[100:103], v[208:211], v[52:55]
    v_mfma_f32_16x16x32_bf16 v[8:11], v[104:107], v[196:199], v[8:11]
    v_mfma_f32_16x16x32_bf16 v[24:27], v[104:107], v[200:203], v[24:27]
    v_mfma_f32_16x16x32_bf16 v[40:43], v[104:107], v[204:207], v[40:43]
    v_mfma_f32_16x16x32_bf16 v[56:59], v[104:107], v[208:211], v[56:59]
    v_mfma_f32_16x16x32_bf16 v[12:15], v[108:111], v[196:199], v[12:15]
    v_mfma_f32_16x16x32_bf16 v[28:31], v[108:111], v[200:203], v[28:31]
    v_mfma_f32_16x16x32_bf16 v[44:47], v[108:111], v[204:207], v[44:47]
    v_mfma_f32_16x16x32_bf16 v[60:63], v[108:111], v[208:211], v[60:63]
    v_mfma_f32_16x16x32_bf16 v[16:19], v[112:115], v[196:199], v[16:19]
    v_mfma_f32_16x16x32_bf16 v[32:35], v[112:115], v[200:203], v[32:35]
    v_mfma_f32_16x16x32_bf16 v[48:51], v[112:115], v[204:207], v[48:51]
    v_mfma_f32_16x16x32_bf16 v[64:67], v[112:115], v[208:211], v[64:67]
    s_add_u32 s70, s69, 22528
    buffer_load_dwordx4 v[196:199], v2, s[40:43], s70 offen offset:0
    buffer_load_dwordx4 v[200:203], v2, s[40:43], s70 offen offset:1024
    buffer_load_dwordx4 v[204:207], v2, s[40:43], s70 offen offset:2048
    buffer_load_dwordx4 v[208:211], v2, s[40:43], s70 offen offset:3072
    s_waitcnt vmcnt(26)
    v_mfma_f32_16x16x16_bf16 v[4:7], v[116:117], v[212:213], v[4:7]
    v_mfma_f32_16x16x16_bf16 v[20:23], v[116:117], v[216:217], v[20:23]
    v_mfma_f32_16x16x16_bf16 v[36:39], v[116:117], v[220:221], v[36:39]
    v_mfma_f32_16x16x16_bf16 v[52:55], v[116:117], v[224:225], v[52:55]
    v_mfma_f32_16x16x16_bf16 v[8:11], v[120:121], v[212:213], v[8:11]
    v_mfma_f32_16x16x16_bf16 v[24:27], v[120:121], v[216:217], v[24:27]
    v_mfma_f32_16x16x16_bf16 v[40:43], v[120:121], v[220:221], v[40:43]
    v_mfma_f32_16x16x16_bf16 v[56:59], v[120:121], v[224:225], v[56:59]
    v_mfma_f32_16x16x16_bf16 v[12:15], v[124:125], v[212:213], v[12:15]
    v_mfma_f32_16x16x16_bf16 v[28:31], v[124:125], v[216:217], v[28:31]
    v_mfma_f32_16x16x16_bf16 v[44:47], v[124:125], v[220:221], v[44:47]
    v_mfma_f32_16x16x16_bf16 v[60:63], v[124:125], v[224:225], v[60:63]
    v_mfma_f32_16x16x16_bf16 v[16:19], v[128:129], v[212:213], v[16:19]
    v_mfma_f32_16x16x16_bf16 v[32:35], v[128:129], v[216:217], v[32:35]
    v_mfma_f32_16x16x16_bf16 v[48:51], v[128:129], v[220:221], v[48:51]
    v_mfma_f32_16x16x16_bf16 v[64:67], v[128:129], v[224:225], v[64:67]
    s_add_u32 s70, s69, 26624
    buffer_load_dwordx2 v[212:213], v244, s[40:43], s70 offen offset:0
    buffer_load_dwordx2 v[216:217], v244, s[40:43], s70 offen offset:512
    buffer_load_dwordx2 v[220:221], v244, s[40:43], s70 offen offset:1024
    buffer_load_dwordx2 v[224:225], v244, s[40:43], s70 offen offset:1536
    s_waitcnt vmcnt(12)
    v_mfma_f32_16x16x32_bf16 v[4:7], v[132:135], v[164:167], v[4:7]
    v_mfma_f32_16x16x32_bf16 v[20:23], v[132:135], v[168:171], v[20:23]
    v_mfma_f32_16x16x32_bf16 v[36:39], v[132:135], v[172:175], v[36:39]
    v_mfma_f32_16x16x32_bf16 v[52:55], v[132:135], v[176:179], v[52:55]
    v_mfma_f32_16x16x32_bf16 v[8:11], v[136:139], v[164:167], v[8:11]
    v_mfma_f32_16x16x32_bf16 v[24:27], v[136:139], v[168:171], v[24:27]
    v_mfma_f32_16x16x32_bf16 v[40:43], v[136:139], v[172:175], v[40:43]
    v_mfma_f32_16x16x32_bf16 v[56:59], v[136:139], v[176:179], v[56:59]
    v_mfma_f32_16x16x32_bf16 v[12:15], v[140:143], v[164:167], v[12:15]
    v_mfma_f32_16x16x32_bf16 v[28:31], v[140:143], v[168:171], v[28:31]
    v_mfma_f32_16x16x32_bf16 v[44:47], v[140:143], v[172:175], v[44:47]
    v_mfma_f32_16x16x32_bf16 v[60:63], v[140:143], v[176:179], v[60:63]
    v_mfma_f32_16x16x32_bf16 v[16:19], v[144:147], v[164:167], v[16:19]
    v_mfma_f32_16x16x32_bf16 v[32:35], v[144:147], v[168:171], v[32:35]
    v_mfma_f32_16x16x32_bf16 v[48:51], v[144:147], v[172:175], v[48:51]
    v_mfma_f32_16x16x32_bf16 v[64:67], v[144:147], v[176:179], v[64:67]
    s_bitcmp1_b32 s61, 2
    s_cbranch_scc1 FG_HW5_D
    s_mov_b32 s76, 1048576
FG_HW5:
    buffer_load_dword v230, v248, s[52:55], s3 offen sc1
    s_waitcnt vmcnt(0)
    v_cmp_eq_u32 vcc, s34, v230
    s_and_b32 s61, vcc_lo, 15
    s_bitcmp1_b32 s61, 2
    s_cbranch_scc1 FG_HW5_D
    s_sleep 2
    s_sub_u32 s76, s76, 1
    s_cmp_lg_u32 s76, 0
    s_cbranch_scc1 FG_HW5
FG_HW5_D:
    s_add_u32 s70, s69, 28672
    buffer_load_dwordx4 v[164:167], v2, s[40:43], s70 offen offset:0
    buffer_load_dwordx4 v[168:171], v2, s[40:43], s70 offen offset:1024
    buffer_load_dwordx4 v[172:175], v2, s[40:43], s70 offen offset:2048
    buffer_load_dwordx4 v[176:179], v2, s[40:43], s70 offen offset:3072
    s_add_u32 s70, s68, 36864
    buffer_load_dwordx4 v[132:135], v2, s[36:39], s70 offen offset:0
    buffer_load_dwordx4 v[136:139], v2, s[36:39], s70 offen offset:1024
    buffer_load_dwordx4 v[140:143], v2, s[36:39], s70 offen offset:2048
    buffer_load_dwordx4 v[144:147], v2, s[36:39], s70 offen offset:3072
    s_waitcnt vmcnt(34)
    ds_read_b128 v[68:71], v246 offset:0
    ds_read_b128 v[72:75], v246 offset:1024
    ds_read_b128 v[76:79], v246 offset:2048
    ds_read_b128 v[80:83], v246 offset:3072
    s_waitcnt vmcnt(16)
    v_mfma_f32_16x16x32_bf16 v[4:7], v[148:151], v[180:183], v[4:7]
    v_mfma_f32_16x16x32_bf16 v[20:23], v[148:151], v[184:187], v[20:23]
    v_mfma_f32_16x16x32_bf16 v[36:39], v[148:151], v[188:191], v[36:39]
    v_mfma_f32_16x16x32_bf16 v[52:55], v[148:151], v[192:195], v[52:55]
    v_mfma_f32_16x16x32_bf16 v[8:11], v[152:155], v[180:183], v[8:11]
    v_mfma_f32_16x16x32_bf16 v[24:27], v[152:155], v[184:187], v[24:27]
    v_mfma_f32_16x16x32_bf16 v[40:43], v[152:155], v[188:191], v[40:43]
    v_mfma_f32_16x16x32_bf16 v[56:59], v[152:155], v[192:195], v[56:59]
    v_mfma_f32_16x16x32_bf16 v[12:15], v[156:159], v[180:183], v[12:15]
    v_mfma_f32_16x16x32_bf16 v[28:31], v[156:159], v[184:187], v[28:31]
    v_mfma_f32_16x16x32_bf16 v[44:47], v[156:159], v[188:191], v[44:47]
    v_mfma_f32_16x16x32_bf16 v[60:63], v[156:159], v[192:195], v[60:63]
    v_mfma_f32_16x16x32_bf16 v[16:19], v[160:163], v[180:183], v[16:19]
    v_mfma_f32_16x16x32_bf16 v[32:35], v[160:163], v[184:187], v[32:35]
    v_mfma_f32_16x16x32_bf16 v[48:51], v[160:163], v[188:191], v[48:51]
    v_mfma_f32_16x16x32_bf16 v[64:67], v[160:163], v[192:195], v[64:67]
    s_add_u32 s70, s69, 32768
    buffer_load_dwordx4 v[180:183], v2, s[40:43], s70 offen offset:0
    buffer_load_dwordx4 v[184:187], v2, s[40:43], s70 offen offset:1024
    buffer_load_dwordx4 v[188:191], v2, s[40:43], s70 offen offset:2048
    buffer_load_dwordx4 v[192:195], v2, s[40:43], s70 offen offset:3072
    s_add_u32 s70, s68, 40960
    buffer_load_dwordx2 v[148:149], v244, s[36:39], s70 offen offset:0
    buffer_load_dwordx2 v[152:153], v244, s[36:39], s70 offen offset:512
    buffer_load_dwordx2 v[156:157], v244, s[36:39], s70 offen offset:1024
    buffer_load_dwordx2 v[160:161], v244, s[36:39], s70 offen offset:1536
    s_waitcnt vmcnt(40)
    ds_read_b64 v[84:85], v247 offset:4096
    ds_read_b64 v[88:89], v247 offset:4608
    ds_read_b64 v[92:93], v247 offset:5120
    ds_read_b64 v[96:97], v247 offset:5632
    s_waitcnt vmcnt(20)
    s_waitcnt lgkmcnt(0)
    v_mfma_f32_16x16x32_bf16 v[4:7], v[68:71], v[196:199], v[4:7]
    v_mfma_f32_16x16x32_bf16 v[20:23], v[68:71], v[200:203], v[20:23]
    v_mfma_f32_16x16x32_bf16 v[36:39], v[68:71], v[204:207], v[36:39]
    v_mfma_f32_16x16x32_bf16 v[52:55], v[68:71], v[208:211], v[52:55]
    v_mfma_f32_16x16x32_bf16 v[8:11], v[72:75], v[196:199], v[8:11]
    v_mfma_f32_16x16x32_bf16 v[24:27], v[72:75], v[200:203], v[24:27]
    v_mfma_f32_16x16x32_bf16 v[40:43], v[72:75], v[204:207], v[40:43]
    v_mfma_f32_16x16x32_bf16 v[56:59], v[72:75], v[208:211], v[56:59]
    v_mfma_f32_16x16x32_bf16 v[12:15], v[76:79], v[196:199], v[12:15]
    v_mfma_f32_16x16x32_bf16 v[28:31], v[76:79], v[200:203], v[28:31]
    v_mfma_f32_16x16x32_bf16 v[44:47], v[76:79], v[204:207], v[44:47]
    v_mfma_f32_16x16x32_bf16 v[60:63], v[76:79], v[208:211], v[60:63]
    v_mfma_f32_16x16x32_bf16 v[16:19], v[80:83], v[196:199], v[16:19]
    v_mfma_f32_16x16x32_bf16 v[32:35], v[80:83], v[200:203], v[32:35]
    v_mfma_f32_16x16x32_bf16 v[48:51], v[80:83], v[204:207], v[48:51]
    v_mfma_f32_16x16x32_bf16 v[64:67], v[80:83], v[208:211], v[64:67]
    s_add_u32 s70, s69, 36864
    buffer_load_dwordx4 v[196:199], v2, s[40:43], s70 offen offset:0
    buffer_load_dwordx4 v[200:203], v2, s[40:43], s70 offen offset:1024
    buffer_load_dwordx4 v[204:207], v2, s[40:43], s70 offen offset:2048
    buffer_load_dwordx4 v[208:211], v2, s[40:43], s70 offen offset:3072
    s_add_u32 s70, s68, 43008
    buffer_load_dwordx4 v[68:71], v2, s[36:39], s70 offen offset:0
    buffer_load_dwordx4 v[72:75], v2, s[36:39], s70 offen offset:1024
    buffer_load_dwordx4 v[76:79], v2, s[36:39], s70 offen offset:2048
    buffer_load_dwordx4 v[80:83], v2, s[36:39], s70 offen offset:3072
    s_waitcnt vmcnt(44)
    ds_read_b128 v[100:103], v246 offset:8192
    ds_read_b128 v[104:107], v246 offset:9216
    ds_read_b128 v[108:111], v246 offset:10240
    ds_read_b128 v[112:115], v246 offset:11264
    s_waitcnt vmcnt(24)
    s_waitcnt lgkmcnt(0)
    v_mfma_f32_16x16x16_bf16 v[4:7], v[84:85], v[212:213], v[4:7]
    v_mfma_f32_16x16x16_bf16 v[20:23], v[84:85], v[216:217], v[20:23]
    v_mfma_f32_16x16x16_bf16 v[36:39], v[84:85], v[220:221], v[36:39]
    v_mfma_f32_16x16x16_bf16 v[52:55], v[84:85], v[224:225], v[52:55]
    v_mfma_f32_16x16x16_bf16 v[8:11], v[88:89], v[212:213], v[8:11]
    v_mfma_f32_16x16x16_bf16 v[24:27], v[88:89], v[216:217], v[24:27]
    v_mfma_f32_16x16x16_bf16 v[40:43], v[88:89], v[220:221], v[40:43]
    v_mfma_f32_16x16x16_bf16 v[56:59], v[88:89], v[224:225], v[56:59]
    v_mfma_f32_16x16x16_bf16 v[12:15], v[92:93], v[212:213], v[12:15]
    v_mfma_f32_16x16x16_bf16 v[28:31], v[92:93], v[216:217], v[28:31]
    v_mfma_f32_16x16x16_bf16 v[44:47], v[92:93], v[220:221], v[44:47]
    v_mfma_f32_16x16x16_bf16 v[60:63], v[92:93], v[224:225], v[60:63]
    v_mfma_f32_16x16x16_bf16 v[16:19], v[96:97], v[212:213], v[16:19]
    v_mfma_f32_16x16x16_bf16 v[32:35], v[96:97], v[216:217], v[32:35]
    v_mfma_f32_16x16x16_bf16 v[48:51], v[96:97], v[220:221], v[48:51]
    v_mfma_f32_16x16x16_bf16 v[64:67], v[96:97], v[224:225], v[64:67]
    s_add_u32 s70, s69, 40960
    buffer_load_dwordx2 v[212:213], v244, s[40:43], s70 offen offset:0
    buffer_load_dwordx2 v[216:217], v244, s[40:43], s70 offen offset:512
    buffer_load_dwordx2 v[220:221], v244, s[40:43], s70 offen offset:1024
    buffer_load_dwordx2 v[224:225], v244, s[40:43], s70 offen offset:1536
    s_add_u32 s70, s68, 47104
    buffer_load_dwordx4 v[84:87], v2, s[36:39], s70 offen offset:0
    buffer_load_dwordx4 v[88:91], v2, s[36:39], s70 offen offset:1024
    buffer_load_dwordx4 v[92:95], v2, s[36:39], s70 offen offset:2048
    buffer_load_dwordx4 v[96:99], v2, s[36:39], s70 offen offset:3072
    s_waitcnt vmcnt(48)
    ds_read_b128 v[116:119], v246 offset:12288
    ds_read_b128 v[120:123], v246 offset:13312
    ds_read_b128 v[124:127], v246 offset:14336
    ds_read_b128 v[128:131], v246 offset:15360
    s_waitcnt vmcnt(28)
    s_waitcnt lgkmcnt(0)
    v_mfma_f32_16x16x32_bf16 v[4:7], v[100:103], v[164:167], v[4:7]
    v_mfma_f32_16x16x32_bf16 v[20:23], v[100:103], v[168:171], v[20:23]
    v_mfma_f32_16x16x32_bf16 v[36:39], v[100:103], v[172:175], v[36:39]
    v_mfma_f32_16x16x32_bf16 v[52:55], v[100:103], v[176:179], v[52:55]
    v_mfma_f32_16x16x32_bf16 v[8:11], v[104:107], v[164:167], v[8:11]
    v_mfma_f32_16x16x32_bf16 v[24:27], v[104:107], v[168:171], v[24:27]
    v_mfma_f32_16x16x32_bf16 v[40:43], v[104:107], v[172:175], v[40:43]
    v_mfma_f32_16x16x32_bf16 v[56:59], v[104:107], v[176:179], v[56:59]
    v_mfma_f32_16x16x32_bf16 v[12:15], v[108:111], v[164:167], v[12:15]
    v_mfma_f32_16x16x32_bf16 v[28:31], v[108:111], v[168:171], v[28:31]
    v_mfma_f32_16x16x32_bf16 v[44:47], v[108:111], v[172:175], v[44:47]
    v_mfma_f32_16x16x32_bf16 v[60:63], v[108:111], v[176:179], v[60:63]
    v_mfma_f32_16x16x32_bf16 v[16:19], v[112:115], v[164:167], v[16:19]
    v_mfma_f32_16x16x32_bf16 v[32:35], v[112:115], v[168:171], v[32:35]
    v_mfma_f32_16x16x32_bf16 v[48:51], v[112:115], v[172:175], v[48:51]
    v_mfma_f32_16x16x32_bf16 v[64:67], v[112:115], v[176:179], v[64:67]
    s_bitcmp1_b32 s61, 3
    s_cbranch_scc1 FG_HW6_D
    s_mov_b32 s76, 1048576
FG_HW6:
    buffer_load_dword v230, v248, s[52:55], s3 offen sc1
    s_waitcnt vmcnt(0)
    v_cmp_eq_u32 vcc, s34, v230
    s_and_b32 s61, vcc_lo, 15
    s_bitcmp1_b32 s61, 3
    s_cbranch_scc1 FG_HW6_D
    s_sleep 2
    s_sub_u32 s76, s76, 1
    s_cmp_lg_u32 s76, 0
    s_cbranch_scc1 FG_HW6
FG_HW6_D:
    s_add_u32 s70, s69, 43008
    buffer_load_dwordx4 v[164:167], v2, s[40:43], s70 offen offset:0
    buffer_load_dwordx4 v[168:171], v2, s[40:43], s70 offen offset:1024
    buffer_load_dwordx4 v[172:175], v2, s[40:43], s70 offen offset:2048
    buffer_load_dwordx4 v[176:179], v2, s[40:43], s70 offen offset:3072
    s_add_u32 s70, s68, 51200
    buffer_load_dwordx4 v[100:103], v2, s[36:39], s70 offen offset:0
    buffer_load_dwordx4 v[104:107], v2, s[36:39], s70 offen offset:1024
    buffer_load_dwordx4 v[108:111], v2, s[36:39], s70 offen offset:2048
    buffer_load_dwordx4 v[112:115], v2, s[36:39], s70 offen offset:3072
    s_waitcnt vmcnt(28)
    s_waitcnt lgkmcnt(0)
    v_mfma_f32_16x16x32_bf16 v[4:7], v[116:119], v[180:183], v[4:7]
    v_mfma_f32_16x16x32_bf16 v[20:23], v[116:119], v[184:187], v[20:23]
    v_mfma_f32_16x16x32_bf16 v[36:39], v[116:119], v[188:191], v[36:39]
    v_mfma_f32_16x16x32_bf16 v[52:55], v[116:119], v[192:195], v[52:55]
    v_mfma_f32_16x16x32_bf16 v[8:11], v[120:123], v[180:183], v[8:11]
    v_mfma_f32_16x16x32_bf16 v[24:27], v[120:123], v[184:187], v[24:27]
    v_mfma_f32_16x16x32_bf16 v[40:43], v[120:123], v[188:191], v[40:43]
    v_mfma_f32_16x16x32_bf16 v[56:59], v[120:123], v[192:195], v[56:59]
    v_mfma_f32_16x16x32_bf16 v[12:15], v[124:127], v[180:183], v[12:15]
    v_mfma_f32_16x16x32_bf16 v[28:31], v[124:127], v[184:187], v[28:31]
    v_mfma_f32_16x16x32_bf16 v[44:47], v[124:127], v[188:191], v[44:47]
    v_mfma_f32_16x16x32_bf16 v[60:63], v[124:127], v[192:195], v[60:63]
    v_mfma_f32_16x16x32_bf16 v[16:19], v[128:131], v[180:183], v[16:19]
    v_mfma_f32_16x16x32_bf16 v[32:35], v[128:131], v[184:187], v[32:35]
    v_mfma_f32_16x16x32_bf16 v[48:51], v[128:131], v[188:191], v[48:51]
    v_mfma_f32_16x16x32_bf16 v[64:67], v[128:131], v[192:195], v[64:67]
    s_add_u32 s70, s69, 47104
    buffer_load_dwordx4 v[180:183], v2, s[40:43], s70 offen offset:0
    buffer_load_dwordx4 v[184:187], v2, s[40:43], s70 offen offset:1024
    buffer_load_dwordx4 v[188:191], v2, s[40:43], s70 offen offset:2048
    buffer_load_dwordx4 v[192:195], v2, s[40:43], s70 offen offset:3072
    s_add_u32 s70, s68, 55296
    buffer_load_dwordx2 v[116:117], v244, s[36:39], s70 offen offset:0
    buffer_load_dwordx2 v[120:121], v244, s[36:39], s70 offen offset:512
    buffer_load_dwordx2 v[124:125], v244, s[36:39], s70 offen offset:1024
    buffer_load_dwordx2 v[128:129], v244, s[36:39], s70 offen offset:1536
    s_waitcnt vmcnt(28)
    v_mfma_f32_16x16x32_bf16 v[4:7], v[132:135], v[196:199], v[4:7]
    v_mfma_f32_16x16x32_bf16 v[20:23], v[132:135], v[200:203], v[20:23]
    v_mfma_f32_16x16x32_bf16 v[36:39], v[132:135], v[204:207], v[36:39]
    v_mfma_f32_16x16x32_bf16 v[52:55], v[132:135], v[208:211], v[52:55]
    v_mfma_f32_16x16x32_bf16 v[8:11], v[136:139], v[196:199], v[8:11]
    v_mfma_f32_16x16x32_bf16 v[24:27], v[136:139], v[200:203], v[24:27]
    v_mfma_f32_16x16x32_bf16 v[40:43], v[136:139], v[204:207], v[40:43]
    v_mfma_f32_16x16x32_bf16 v[56:59], v[136:139], v[208:211], v[56:59]
    v_mfma_f32_16x16x32_bf16 v[12:15], v[140:143], v[196:199], v[12:15]
    v_mfma_f32_16x16x32_bf16 v[28:31], v[140:143], v[200:203], v[28:31]
    v_mfma_f32_16x16x32_bf16 v[44:47], v[140:143], v[204:207], v[44:47]
    v_mfma_f32_16x16x32_bf16 v[60:63], v[140:143], v[208:211], v[60:63]
    v_mfma_f32_16x16x32_bf16 v[16:19], v[144:147], v[196:199], v[16:19]
    v_mfma_f32_16x16x32_bf16 v[32:35], v[144:147], v[200:203], v[32:35]
    v_mfma_f32_16x16x32_bf16 v[48:51], v[144:147], v[204:207], v[48:51]
    v_mfma_f32_16x16x32_bf16 v[64:67], v[144:147], v[208:211], v[64:67]
    s_add_u32 s70, s69, 51200
    buffer_load_dwordx4 v[196:199], v2, s[40:43], s70 offen offset:0
    buffer_load_dwordx4 v[200:203], v2, s[40:43], s70 offen offset:1024
    buffer_load_dwordx4 v[204:207], v2, s[40:43], s70 offen offset:2048
    buffer_load_dwordx4 v[208:211], v2, s[40:43], s70 offen offset:3072
    s_lshl_b32 s77, s66, 7
    s_add_u32 s77, s77, 3072
    buffer_load_dword v228, v245, s[52:55], s77 offen sc1
    s_waitcnt vmcnt(25)
    v_mfma_f32_16x16x16_bf16 v[4:7], v[148:149], v[212:213], v[4:7]
    v_mfma_f32_16x16x16_bf16 v[20:23], v[148:149], v[216:217], v[20:23]
    v_mfma_f32_16x16x16_bf16 v[36:39], v[148:149], v[220:221], v[36:39]
    v_mfma_f32_16x16x16_bf16 v[52:55], v[148:149], v[224:225], v[52:55]
    v_mfma_f32_16x16x16_bf16 v[8:11], v[152:153], v[212:213], v[8:11]
    v_mfma_f32_16x16x16_bf16 v[24:27], v[152:153], v[216:217], v[24:27]
    v_mfma_f32_16x16x16_bf16 v[40:43], v[152:153], v[220:221], v[40:43]
    v_mfma_f32_16x16x16_bf16 v[56:59], v[152:153], v[224:225], v[56:59]
    v_mfma_f32_16x16x16_bf16 v[12:15], v[156:157], v[212:213], v[12:15]
    v_mfma_f32_16x16x16_bf16 v[28:31], v[156:157], v[216:217], v[28:31]
    v_mfma_f32_16x16x16_bf16 v[44:47], v[156:157], v[220:221], v[44:47]
    v_mfma_f32_16x16x16_bf16 v[60:63], v[156:157], v[224:225], v[60:63]
    v_mfma_f32_16x16x16_bf16 v[16:19], v[160:161], v[212:213], v[16:19]
    v_mfma_f32_16x16x16_bf16 v[32:35], v[160:161], v[216:217], v[32:35]
    v_mfma_f32_16x16x16_bf16 v[48:51], v[160:161], v[220:221], v[48:51]
    v_mfma_f32_16x16x16_bf16 v[64:67], v[160:161], v[224:225], v[64:67]
    s_add_u32 s70, s69, 55296
    buffer_load_dwordx2 v[212:213], v244, s[40:43], s70 offen offset:0
    buffer_load_dwordx2 v[216:217], v244, s[40:43], s70 offen offset:512
    buffer_load_dwordx2 v[220:221], v244, s[40:43], s70 offen offset:1024
    buffer_load_dwordx2 v[224:225], v244, s[40:43], s70 offen offset:1536
    s_waitcnt vmcnt(21)
    v_mfma_f32_16x16x32_bf16 v[4:7], v[68:71], v[164:167], v[4:7]
    v_mfma_f32_16x16x32_bf16 v[20:23], v[68:71], v[168:171], v[20:23]
    v_mfma_f32_16x16x32_bf16 v[36:39], v[68:71], v[172:175], v[36:39]
    v_mfma_f32_16x16x32_bf16 v[52:55], v[68:71], v[176:179], v[52:55]
    v_mfma_f32_16x16x32_bf16 v[8:11], v[72:75], v[164:167], v[8:11]
    v_mfma_f32_16x16x32_bf16 v[24:27], v[72:75], v[168:171], v[24:27]
    v_mfma_f32_16x16x32_bf16 v[40:43], v[72:75], v[172:175], v[40:43]
    v_mfma_f32_16x16x32_bf16 v[56:59], v[72:75], v[176:179], v[56:59]
    v_mfma_f32_16x16x32_bf16 v[12:15], v[76:79], v[164:167], v[12:15]
    v_mfma_f32_16x16x32_bf16 v[28:31], v[76:79], v[168:171], v[28:31]
    v_mfma_f32_16x16x32_bf16 v[44:47], v[76:79], v[172:175], v[44:47]
    v_mfma_f32_16x16x32_bf16 v[60:63], v[76:79], v[176:179], v[60:63]
    v_mfma_f32_16x16x32_bf16 v[16:19], v[80:83], v[164:167], v[16:19]
    v_mfma_f32_16x16x32_bf16 v[32:35], v[80:83], v[168:171], v[32:35]
    v_mfma_f32_16x16x32_bf16 v[48:51], v[80:83], v[172:175], v[48:51]
    v_mfma_f32_16x16x32_bf16 v[64:67], v[80:83], v[176:179], v[64:67]
    s_waitcnt vmcnt(4)
    v_cmp_ne_u32 vcc, s34, v228
    s_mov_b32 s62, vcc_lo
    s_cmp_eq_u32 s62, 0
    s_cbranch_scc0 FG_SN
    s_lshl_b32 s70, s66, 18
    s_lshl_b32 s71, s60, 16
    s_add_u32 s70, s70, s71
    s_lshl_b32 s71, s65, 7
    s_add_u32 s70, s70, s71
    s_lshl_b32 s71, s60, 11
    s_add_u32 s71, s71, 65536
    s_mov_b32 m0, s71
    s_nop 0
    buffer_load_dwordx4 v249, s[44:47], s70 offen lds
    s_add_u32 s70, s70, 32768
    s_add_u32 s71, s71, 1024
    s_mov_b32 m0, s71
    s_nop 0
    buffer_load_dwordx4 v249, s[44:47], s70 offen lds
    s_branch FG_SJ
FG_SN:
    buffer_load_dword v229, v245, s[56:59], 0 offen
    buffer_load_dword v229, v245, s[56:59], 0 offen
FG_SJ:
    s_waitcnt vmcnt(15)
    v_mfma_f32_16x16x32_bf16 v[4:7], v[84:87], v[180:183], v[4:7]
    v_mfma_f32_16x16x32_bf16 v[20:23], v[84:87], v[184:187], v[20:23]
    v_mfma_f32_16x16x32_bf16 v[36:39], v[84:87], v[188:191], v[36:39]
    v_mfma_f32_16x16x32_bf16 v[52:55], v[84:87], v[192:195], v[52:55]
    v_mfma_f32_16x16x32_bf16 v[8:11], v[88:91], v[180:183], v[8:11]
    v_mfma_f32_16x16x32_bf16 v[24:27], v[88:91], v[184:187], v[24:27]
    v_mfma_f32_16x16x32_bf16 v[40:43], v[88:91], v[188:191], v[40:43]
    v_mfma_f32_16x16x32_bf16 v[56:59], v[88:91], v[192:195], v[56:59]
    v_mfma_f32_16x16x32_bf16 v[12:15], v[92:95], v[180:183], v[12:15]
    v_mfma_f32_16x16x32_bf16 v[28:31], v[92:95], v[184:187], v[28:31]
    v_mfma_f32_16x16x32_bf16 v[44:47], v[92:95], v[188:191], v[44:47]
    v_mfma_f32_16x16x32_bf16 v[60:63], v[92:95], v[192:195], v[60:63]
    v_mfma_f32_16x16x32_bf16 v[16:19], v[96:99], v[180:183], v[16:19]
    v_mfma_f32_16x16x32_bf16 v[32:35], v[96:99], v[184:187], v[32:35]
    v_mfma_f32_16x16x32_bf16 v[48:51], v[96:99], v[188:191], v[48:51]
    v_mfma_f32_16x16x32_bf16 v[64:67], v[96:99], v[192:195], v[64:67]
    s_waitcnt vmcnt(7)
    v_mfma_f32_16x16x32_bf16 v[4:7], v[100:103], v[196:199], v[4:7]
    v_mfma_f32_16x16x32_bf16 v[20:23], v[100:103], v[200:203], v[20:23]
    v_mfma_f32_16x16x32_bf16 v[36:39], v[100:103], v[204:207], v[36:39]
    v_mfma_f32_16x16x32_bf16 v[52:55], v[100:103], v[208:211], v[52:55]
    v_mfma_f32_16x16x32_bf16 v[8:11], v[104:107], v[196:199], v[8:11]
    v_mfma_f32_16x16x32_bf16 v[24:27], v[104:107], v[200:203], v[24:27]
    v_mfma_f32_16x16x32_bf16 v[40:43], v[104:107], v[204:207], v[40:43]
    v_mfma_f32_16x16x32_bf16 v[56:59], v[104:107], v[208:211], v[56:59]
    v_mfma_f32_16x16x32_bf16 v[12:15], v[108:111], v[196:199], v[12:15]
    v_mfma_f32_16x16x32_bf16 v[28:31], v[108:111], v[200:203], v[28:31]
    v_mfma_f32_16x16x32_bf16 v[44:47], v[108:111], v[204:207], v[44:47]
    v_mfma_f32_16x16x32_bf16 v[60:63], v[108:111], v[208:211], v[60:63]
    v_mfma_f32_16x16x32_bf16 v[16:19], v[112:115], v[196:199], v[16:19]
    v_mfma_f32_16x16x32_bf16 v[32:35], v[112:115], v[200:203], v[32:35]
    v_mfma_f32_16x16x32_bf16 v[48:51], v[112:115], v[204:207], v[48:51]
    v_mfma_f32_16x16x32_bf16 v[64:67], v[112:115], v[208:211], v[64:67]
    s_waitcnt vmcnt(2)
    v_mfma_f32_16x16x16_bf16 v[4:7], v[116:117], v[212:213], v[4:7]
    v_mfma_f32_16x16x16_bf16 v[20:23], v[116:117], v[216:217], v[20:23]
    v_mfma_f32_16x16x16_bf16 v[36:39], v[116:117], v[220:221], v[36:39]
    v_mfma_f32_16x16x16_bf16 v[52:55], v[116:117], v[224:225], v[52:55]
    v_mfma_f32_16x16x16_bf16 v[8:11], v[120:121], v[212:213], v[8:11]
    v_mfma_f32_16x16x16_bf16 v[24:27], v[120:121], v[216:217], v[24:27]
    v_mfma_f32_16x16x16_bf16 v[40:43], v[120:121], v[220:221], v[40:43]
    v_mfma_f32_16x16x16_bf16 v[56:59], v[120:121], v[224:225], v[56:59]
    v_mfma_f32_16x16x16_bf16 v[12:15], v[124:125], v[212:213], v[12:15]
    v_mfma_f32_16x16x16_bf16 v[28:31], v[124:125], v[216:217], v[28:31]
    v_mfma_f32_16x16x16_bf16 v[44:47], v[124:125], v[220:221], v[44:47]
    v_mfma_f32_16x16x16_bf16 v[60:63], v[124:125], v[224:225], v[60:63]
    v_mfma_f32_16x16x16_bf16 v[16:19], v[128:129], v[212:213], v[16:19]
    v_mfma_f32_16x16x16_bf16 v[32:35], v[128:129], v[216:217], v[32:35]
    v_mfma_f32_16x16x16_bf16 v[48:51], v[128:129], v[220:221], v[48:51]
    v_mfma_f32_16x16x16_bf16 v[64:67], v[128:129], v[224:225], v[64:67]
    s_cmp_eq_u32 s62, 0
    s_cbranch_scc1 FG_SW
    s_mov_b32 s70, s77
    s_mov_b32 s76, 1048576
    s_mov_b32 s74, 0xffffffff
    s_mov_b32 s75, 0
POLL_FG_7:
    buffer_load_dword v230, v245, s[52:55], s70 offen offset:0 sc1
    s_waitcnt vmcnt(0)
    v_xor_b32 v230, s34, v230
    v_cmp_ne_u32 vcc, 0, v230
    s_and_b64 vcc, vcc, s[74:75]
    s_cbranch_scc0 POLL_FG_7_D
    s_sleep 4
    s_sub_u32 s76, s76, 1
    s_cmp_lg_u32 s76, 0
    s_cbranch_scc1 POLL_FG_7
POLL_FG_7_D:
    s_lshl_b32 s70, s66, 18
    s_lshl_b32 s71, s60, 16
    s_add_u32 s70, s70, s71
    s_lshl_b32 s71, s65, 7
    s_add_u32 s70, s70, s71
    s_lshl_b32 s71, s60, 11
    s_add_u32 s71, s71, 65536
    s_mov_b32 m0, s71
    s_nop 0
    buffer_load_dwordx4 v249, s[44:47], s70 offen lds
    s_add_u32 s70, s70, 32768
    s_add_u32 s71, s71, 1024
    s_mov_b32 m0, s71
    s_nop 0
    buffer_load_dwordx4 v249, s[44:47], s70 offen lds
FG_SW:
    ds_write_b128 v246, v[4:7] offset:0
    ds_write_b128 v246, v[8:11] offset:1024
    ds_write_b128 v246, v[12:15] offset:2048
    ds_write_b128 v246, v[16:19] offset:3072
    ds_write_b128 v246, v[20:23] offset:4096
    ds_write_b128 v246, v[24:27] offset:5120
    ds_write_b128 v246, v[28:31] offset:6144
    ds_write_b128 v246, v[32:35] offset:7168
    ds_write_b128 v246, v[36:39] offset:8192
    ds_write_b128 v246, v[40:43] offset:9216
    ds_write_b128 v246, v[44:47] offset:10240
    ds_write_b128 v246, v[48:51] offset:11264
    ds_write_b128 v246, v[52:55] offset:12288
    ds_write_b128 v246, v[56:59] offset:13312
    ds_write_b128 v246, v[60:63] offset:14336
    ds_write_b128 v246, v[64:67] offset:15360
    v_and_b32 v230, 15, v1
    v_lshrrev_b32 v231, 4, v1
    s_lshl_b32 s71, s60, 4
    v_add_u32 v232, s71, v230
    v_lshlrev_b32 v234, 7, v232
    v_lshl_add_u32 v234, v231, 3, v234
    v_add_u32 v234, 0x12000, v234
    v_lshlrev_b32 v235, 9, v231
    v_lshl_add_u32 v235, v232, 1, v235
    v_add_u32 v235, 0x10000, v235
    s_lshl_b32 s70, s65, 6
    v_add_u32 v232, s70, v232
    v_lshlrev_b32 v233, 10, v232
    v_lshl_add_u32 v233, v231, 3, v233
    s_lshl_b32 s73, s66, 7
    s_lshl_b32 s70, s60, 12
    v_add_u32 v246, s70, v2
    s_mov_b32 s74, 0xbfb8aa3b
    s_waitcnt vmcnt(0) lgkmcnt(0)
    s_barrier
    ds_read_b128 v[68:71], v246 offset:0
    ds_read_b128 v[72:75], v246 offset:1024
    ds_read_b128 v[76:79], v246 offset:2048
    ds_read_b128 v[80:83], v246 offset:3072
    ds_read_b128 v[84:87], v246 offset:16384
    ds_read_b128 v[88:91], v246 offset:17408
    ds_read_b128 v[92:95], v246 offset:18432
    ds_read_b128 v[96:99], v246 offset:19456
    ds_read_b128 v[100:103], v246 offset:32768
    ds_read_b128 v[104:107], v246 offset:33792
    ds_read_b128 v[108:111], v246 offset:34816
    ds_read_b128 v[112:115], v246 offset:35840
    ds_read_b128 v[116:119], v246 offset:49152
    ds_read_b128 v[120:123], v246 offset:50176
    ds_read_b128 v[124:127], v246 offset:51200
    ds_read_b128 v[128:131], v246 offset:52224
    s_waitcnt lgkmcnt(8)
    ds_read_b64 v[132:133], v234 offset:0
    ds_read_b64 v[134:135], v234 offset:32
    ds_read_b64 v[136:137], v234 offset:64
    ds_read_b64 v[138:139], v234 offset:96
    v_pk_add_f32 v[68:69], v[68:69], v[84:85]
    v_pk_add_f32 v[70:71], v[70:71], v[86:87]
    v_pk_add_f32 v[72:73], v[72:73], v[88:89]
    v_pk_add_f32 v[74:75], v[74:75], v[90:91]
    v_pk_add_f32 v[76:77], v[76:77], v[92:93]
    v_pk_add_f32 v[78:79], v[78:79], v[94:95]
    v_pk_add_f32 v[80:81], v[80:81], v[96:97]
    v_pk_add_f32 v[82:83], v[82:83], v[98:99]
    s_waitcnt lgkmcnt(4)
    ds_read_u16 v148, v235 offset:0
    ds_read_u16 v149, v235 offset:128
    ds_read_u16 v150, v235 offset:256
    ds_read_u16 v151, v235 offset:384
    ds_read_u16 v152, v235 offset:2048
    ds_read_u16 v153, v235 offset:2176
    ds_read_u16 v154, v235 offset:2304
    ds_read_u16 v155, v235 offset:2432
    v_pk_add_f32 v[100:101], v[100:101], v[116:117]
    v_pk_add_f32 v[102:103], v[102:103], v[118:119]
    v_pk_add_f32 v[104:105], v[104:105], v[120:121]
    v_pk_add_f32 v[106:107], v[106:107], v[122:123]
    v_pk_add_f32 v[108:109], v[108:109], v[124:125]
    v_pk_add_f32 v[110:111], v[110:111], v[126:127]
    v_pk_add_f32 v[112:113], v[112:113], v[128:129]
    v_pk_add_f32 v[114:115], v[114:115], v[130:131]
    v_pk_add_f32 v[68:69], v[68:69], v[100:101]
    v_pk_add_f32 v[70:71], v[70:71], v[102:103]
    v_pk_add_f32 v[72:73], v[72:73], v[104:105]
    v_pk_add_f32 v[74:75], v[74:75], v[106:107]
    v_pk_add_f32 v[76:77], v[76:77], v[108:109]
    v_pk_add_f32 v[78:79], v[78:79], v[110:111]
    v_pk_add_f32 v[80:81], v[80:81], v[112:113]
    v_pk_add_f32 v[82:83], v[82:83], v[114:115]
    s_waitcnt lgkmcnt(4)
    ds_read_u16 v156, v235 offset:4096
    ds_read_u16 v157, v235 offset:4224
    ds_read_u16 v158, v235 offset:4352
    ds_read_u16 v159, v235 offset:4480
    ds_read_u16 v160, v235 offset:6144
    ds_read_u16 v161, v235 offset:6272
    ds_read_u16 v162, v235 offset:6400
    ds_read_u16 v163, v235 offset:6528
    v_cvt_pk_bf16_f32 v4, v68, v69
    v_cvt_pk_bf16_f32 v5, v70, v71
    v_cvt_pk_bf16_f32 v6, v72, v73
    v_cvt_pk_bf16_f32 v7, v74, v75
    v_cvt_pk_bf16_f32 v8, v76, v77
    v_cvt_pk_bf16_f32 v9, v78, v79
    v_cvt_pk_bf16_f32 v10, v80, v81
    v_cvt_pk_bf16_f32 v11, v82, v83
    v_lshlrev_b32 v68, 16, v4
    v_and_b32 v69, s72, v4
    v_lshlrev_b32 v70, 16, v5
    v_and_b32 v71, s72, v5
    v_lshlrev_b32 v72, 16, v6
    v_and_b32 v73, s72, v6
    v_lshlrev_b32 v74, 16, v7
    v_and_b32 v75, s72, v7
    v_lshlrev_b32 v76, 16, v8
    v_and_b32 v77, s72, v8
    v_lshlrev_b32 v78, 16, v9
    v_and_b32 v79, s72, v9
    v_lshlrev_b32 v80, 16, v10
    v_and_b32 v81, s72, v10
    v_lshlrev_b32 v82, 16, v11
    v_and_b32 v83, s72, v11
    v_lshlrev_b32 v16, 16, v236
    v_and_b32 v17, s72, v236
    v_lshlrev_b32 v18, 16, v237
    v_and_b32 v19, s72, v237
    v_lshlrev_b32 v20, 16, v238
    v_and_b32 v21, s72, v238
    v_lshlrev_b32 v22, 16, v239
    v_and_b32 v23, s72, v239
    v_lshlrev_b32 v24, 16, v240
    v_and_b32 v25, s72, v240
    v_lshlrev_b32 v26, 16, v241
    v_and_b32 v27, s72, v241
    v_lshlrev_b32 v28, 16, v242
    v_and_b32 v29, s72, v242
    v_lshlrev_b32 v30, 16, v243
    v_and_b32 v31, s72, v243
    v_pk_add_f32 v[68:69], v[68:69], v[16:17]
    v_pk_add_f32 v[70:71], v[70:71], v[18:19]
    v_pk_add_f32 v[72:73], v[72:73], v[20:21]
    v_pk_add_f32 v[74:75], v[74:75], v[22:23]
    v_pk_add_f32 v[76:77], v[76:77], v[24:25]
    v_pk_add_f32 v[78:79], v[78:79], v[26:27]
    v_pk_add_f32 v[80:81], v[80:81], v[28:29]
    v_pk_add_f32 v[82:83], v[82:83], v[30:31]
    v_cvt_pk_bf16_f32 v4, v68, v69
    v_cvt_pk_bf16_f32 v5, v70, v71
    v_cvt_pk_bf16_f32 v6, v72, v73
    v_cvt_pk_bf16_f32 v7, v74, v75
    v_cvt_pk_bf16_f32 v8, v76, v77
    v_cvt_pk_bf16_f32 v9, v78, v79
    v_cvt_pk_bf16_f32 v10, v80, v81
    v_cvt_pk_bf16_f32 v11, v82, v83
    v_lshlrev_b32 v68, 16, v4
    v_and_b32 v69, s72, v4
    v_lshlrev_b32 v70, 16, v5
    v_and_b32 v71, s72, v5
    v_lshlrev_b32 v72, 16, v6
    v_and_b32 v73, s72, v6
    v_lshlrev_b32 v74, 16, v7
    v_and_b32 v75, s72, v7
    v_lshlrev_b32 v76, 16, v8
    v_and_b32 v77, s72, v8
    v_lshlrev_b32 v78, 16, v9
    v_and_b32 v79, s72, v9
    v_lshlrev_b32 v80, 16, v10
    v_and_b32 v81, s72, v10
    v_lshlrev_b32 v82, 16, v11
    v_and_b32 v83, s72, v11
    v_mul_f32 v16, s74, v68
    v_mul_f32 v17, s74, v69
    v_mul_f32 v18, s74, v70
    v_mul_f32 v19, s74, v71
    v_mul_f32 v20, s74, v72
    v_mul_f32 v21, s74, v73
    v_mul_f32 v22, s74, v74
    v_mul_f32 v23, s74, v75
    v_mul_f32 v24, s74, v76
    v_mul_f32 v25, s74, v77
    v_mul_f32 v26, s74, v78
    v_mul_f32 v27, s74, v79
    v_mul_f32 v28, s74, v80
    v_mul_f32 v29, s74, v81
    v_mul_f32 v30, s74, v82
    v_mul_f32 v31, s74, v83
    v_exp_f32 v16, v16
    v_exp_f32 v17, v17
    v_exp_f32 v18, v18
    v_exp_f32 v19, v19
    v_exp_f32 v20, v20
    v_exp_f32 v21, v21
    v_exp_f32 v22, v22
    v_exp_f32 v23, v23
    v_exp_f32 v24, v24
    v_exp_f32 v25, v25
    v_exp_f32 v26, v26
    v_exp_f32 v27, v27
    v_exp_f32 v28, v28
    v_exp_f32 v29, v29
    v_exp_f32 v30, v30
    v_exp_f32 v31, v31
    v_pk_add_f32 v[16:17], v[16:17], 1.0 op_sel_hi:[1,0]
    v_pk_add_f32 v[18:19], v[18:19], 1.0 op_sel_hi:[1,0]
    v_pk_add_f32 v[20:21], v[20:21], 1.0 op_sel_hi:[1,0]
    v_pk_add_f32 v[22:23], v[22:23], 1.0 op_sel_hi:[1,0]
    v_pk_add_f32 v[24:25], v[24:25], 1.0 op_sel_hi:[1,0]
    v_pk_add_f32 v[26:27], v[26:27], 1.0 op_sel_hi:[1,0]
    v_pk_add_f32 v[28:29], v[28:29], 1.0 op_sel_hi:[1,0]
    v_pk_add_f32 v[30:31], v[30:31], 1.0 op_sel_hi:[1,0]
    v_rcp_f32 v16, v16
    v_rcp_f32 v17, v17
    v_rcp_f32 v18, v18
    v_rcp_f32 v19, v19
    v_rcp_f32 v20, v20
    v_rcp_f32 v21, v21
    v_rcp_f32 v22, v22
    v_rcp_f32 v23, v23
    v_rcp_f32 v24, v24
    v_rcp_f32 v25, v25
    v_rcp_f32 v26, v26
    v_rcp_f32 v27, v27
    v_rcp_f32 v28, v28
    v_rcp_f32 v29, v29
    v_rcp_f32 v30, v30
    v_rcp_f32 v31, v31
    v_pk_mul_f32 v[68:69], v[68:69], v[16:17]
    v_pk_mul_f32 v[70:71], v[70:71], v[18:19]
    v_pk_mul_f32 v[72:73], v[72:73], v[20:21]
    v_pk_mul_f32 v[74:75], v[74:75], v[22:23]
    v_pk_mul_f32 v[76:77], v[76:77], v[24:25]
    v_pk_mul_f32 v[78:79], v[78:79], v[26:27]
    v_pk_mul_f32 v[80:81], v[80:81], v[28:29]
    v_pk_mul_f32 v[82:83], v[82:83], v[30:31]
    v_cvt_pk_bf16_f32 v4, v68, v69
    v_cvt_pk_bf16_f32 v5, v70, v71
    v_cvt_pk_bf16_f32 v6, v72, v73
    v_cvt_pk_bf16_f32 v7, v74, v75
    v_cvt_pk_bf16_f32 v8, v76, v77
    v_cvt_pk_bf16_f32 v9, v78, v79
    v_cvt_pk_bf16_f32 v10, v80, v81
    v_cvt_pk_bf16_f32 v11, v82, v83
    v_lshlrev_b32 v68, 16, v4
    v_and_b32 v69, s72, v4
    v_lshlrev_b32 v70, 16, v5
    v_and_b32 v71, s72, v5
    v_lshlrev_b32 v72, 16, v6
    v_and_b32 v73, s72, v6
    v_lshlrev_b32 v74, 16, v7
    v_and_b32 v75, s72, v7
    v_lshlrev_b32 v76, 16, v8
    v_and_b32 v77, s72, v8
    v_lshlrev_b32 v78, 16, v9
    v_and_b32 v79, s72, v9
    v_lshlrev_b32 v80, 16, v10
    v_and_b32 v81, s72, v10
    v_lshlrev_b32 v82, 16, v11
    v_and_b32 v83, s72, v11
    s_waitcnt lgkmcnt(0)
    v_lshlrev_b32 v16, 16, v148
    v_lshlrev_b32 v17, 16, v149
    v_lshlrev_b32 v18, 16, v150
    v_lshlrev_b32 v19, 16, v151
    v_lshlrev_b32 v20, 16, v152
    v_lshlrev_b32 v21, 16, v153
    v_lshlrev_b32 v22, 16, v154
    v_lshlrev_b32 v23, 16, v155
    v_lshlrev_b32 v24, 16, v156
    v_lshlrev_b32 v25, 16, v157
    v_lshlrev_b32 v26, 16, v158
    v_lshlrev_b32 v27, 16, v159
    v_lshlrev_b32 v28, 16, v160
    v_lshlrev_b32 v29, 16, v161
    v_lshlrev_b32 v30, 16, v162
    v_lshlrev_b32 v31, 16, v163
    v_pk_mul_f32 v[68:69], v[68:69], v[16:17]
    v_pk_mul_f32 v[70:71], v[70:71], v[18:19]
    v_pk_mul_f32 v[72:73], v[72:73], v[20:21]
    v_pk_mul_f32 v[74:75], v[74:75], v[22:23]
    v_pk_mul_f32 v[76:77], v[76:77], v[24:25]
    v_pk_mul_f32 v[78:79], v[78:79], v[26:27]
    v_pk_mul_f32 v[80:81], v[80:81], v[28:29]
    v_pk_mul_f32 v[82:83], v[82:83], v[30:31]
    v_cvt_pk_bf16_f32 v4, v68, v69
    v_cvt_pk_bf16_f32 v5, v70, v71
    v_cvt_pk_bf16_f32 v6, v72, v73
    v_cvt_pk_bf16_f32 v7, v74, v75
    v_cvt_pk_bf16_f32 v8, v76, v77
    v_cvt_pk_bf16_f32 v9, v78, v79
    v_cvt_pk_bf16_f32 v10, v80, v81
    v_cvt_pk_bf16_f32 v11, v82, v83
    v_lshlrev_b32 v68, 16, v4
    v_and_b32 v69, s72, v4
    v_lshlrev_b32 v70, 16, v5
    v_and_b32 v71, s72, v5
    v_lshlrev_b32 v72, 16, v6
    v_and_b32 v73, s72, v6
    v_lshlrev_b32 v74, 16, v7
    v_and_b32 v75, s72, v7
    v_lshlrev_b32 v76, 16, v8
    v_and_b32 v77, s72, v8
    v_lshlrev_b32 v78, 16, v9
    v_and_b32 v79, s72, v9
    v_lshlrev_b32 v80, 16, v10
    v_and_b32 v81, s72, v10
    v_lshlrev_b32 v82, 16, v11
    v_and_b32 v83, s72, v11
    v_lshlrev_b32 v16, 16, v132
    v_and_b32 v17, s72, v132
    v_lshlrev_b32 v18, 16, v133
    v_and_b32 v19, s72, v133
    v_lshlrev_b32 v20, 16, v134
    v_and_b32 v21, s72, v134
    v_lshlrev_b32 v22, 16, v135
    v_and_b32 v23, s72, v135
    v_lshlrev_b32 v24, 16, v136
    v_and_b32 v25, s72, v136
    v_lshlrev_b32 v26, 16, v137
    v_and_b32 v27, s72, v137
    v_lshlrev_b32 v28, 16, v138
    v_and_b32 v29, s72, v138
    v_lshlrev_b32 v30, 16, v139
    v_and_b32 v31, s72, v139
    v_pk_add_f32 v[68:69], v[68:69], v[16:17]
    v_pk_add_f32 v[70:71], v[70:71], v[18:19]
    v_pk_add_f32 v[72:73], v[72:73], v[20:21]
    v_pk_add_f32 v[74:75], v[74:75], v[22:23]
    v_pk_add_f32 v[76:77], v[76:77], v[24:25]
    v_pk_add_f32 v[78:79], v[78:79], v[26:27]
    v_pk_add_f32 v[80:81], v[80:81], v[28:29]
    v_pk_add_f32 v[82:83], v[82:83], v[30:31]
    v_cvt_pk_bf16_f32 v32, v68, v69
    v_cvt_pk_bf16_f32 v33, v70, v71
    v_cvt_pk_bf16_f32 v34, v72, v73
    v_cvt_pk_bf16_f32 v35, v74, v75
    v_cvt_pk_bf16_f32 v36, v76, v77
    v_cvt_pk_bf16_f32 v37, v78, v79
    v_cvt_pk_bf16_f32 v38, v80, v81
    v_cvt_pk_bf16_f32 v39, v82, v83
    buffer_store_dwordx2 v[32:33], v233, s[48:51], s73 offen offset:0
    buffer_store_dwordx2 v[34:35], v233, s[48:51], s73 offen offset:32
    buffer_store_dwordx2 v[36:37], v233, s[48:51], s73 offen offset:64
    buffer_store_dwordx2 v[38:39], v233, s[48:51], s73 offen offset:96
    s_endpgm
F_C:
    s_sub_u32 s61, s2, 256
    s_and_b32 s62, s61, 7
    s_lshr_b32 s61, s61, 3
    s_lshl_b32 s62, s62, 5
    s_add_u32 s61, s61, s62
    s_lshr_b32 s62, s60, 1
    s_and_b32 s63, s60, 1
    s_lshl_b32 s64, s61, 1
    s_add_u32 s64, s64, s62
    s_mul_i32 s65, s62, 38400
    v_and_b32 v6, 15, v1
    v_lshrrev_b32 v7, 4, v1
    s_mov_b32 s36, s24
    s_mov_b32 s37, s25
    s_mov_b32 s38, 0x1c0000
    s_mov_b32 s39, 0x00020000
    s_add_u32 s40, s32, 0x400000
    s_addc_u32 s41, s33, 0
    s_mov_b32 s42, 0x1c0000
    s_mov_b32 s43, 0x00020000
    s_add_u32 s44, s32, 0x200000
    s_addc_u32 s45, s33, 0
    s_mov_b32 s46, 0x200000
    s_mov_b32 s47, 0x00020000
    s_add_u32 s48, s32, 0xd80000
    s_addc_u32 s49, s33, 0
    s_mov_b32 s50, 0x200000
    s_mov_b32 s51, 0x00020000
    s_add_u32 s52, s32, 0xf80000
    s_addc_u32 s53, s33, 0
    s_mov_b32 s54, 0x14000
    s_mov_b32 s55, 0x00020000
    s_mov_b32 s72, 0xffff0000
    s_lshl_b32 s66, s64, 8
    s_lshl_b32 s67, s63, 7
    s_add_u32 s66, s66, s67
    v_lshl_add_u32 v8, v1, 1, s66
    s_lshl_b32 s67, s64, 1
    v_mov_b32 v9, s67
    global_load_ushort v10, v8, s[6:7]
    global_load_ushort v11, v8, s[8:9]
    global_load_ushort v12, v8, s[10:11]
    global_load_ushort v13, v8, s[12:13]
    global_load_ushort v14, v9, s[14:15]
    global_load_ushort v15, v9, s[16:17]
    v_lshlrev_b32 v17, 3, v0
    v_cvt_f32_u32 v17, v17
    v_cvt_pk_bf16_f32 v17, v17, v17
    v_lshlrev_b32 v17, 16, v17
    v_cvt_u32_f32 v18, v17
    v_lshrrev_b32 v17, 23, v17
    v_subrev_u32 v17, 134, v17
    v_med3_i32 v17, v17, 0, 3
    v_lshrrev_b32 v19, 7, v18
    v_and_b32 v20, 7, v18
    v_lshl_add_u32 v19, v19, 3, v20
    v_lshrrev_b32 v19, v17, v19
    v_lshl_add_u32 v19, v17, 3, v19
    v_bfe_u32 v20, v18, 3, 4
    v_lshrrev_b32 v21, 4, v19
    v_and_b32 v19, 15, v19
    v_lshl_add_u32 v20, v21, 4, v20
    v_lshl_add_u32 v19, v20, 4, v19
    v_lshlrev_b32 v230, 1, v19
    v_lshlrev_b32 v17, 3, v0
    v_add_u32 v17, 1, v17
    v_cvt_f32_u32 v17, v17
    v_cvt_pk_bf16_f32 v17, v17, v17
    v_lshlrev_b32 v17, 16, v17
    v_cvt_u32_f32 v18, v17
    v_lshrrev_b32 v17, 23, v17
    v_subrev_u32 v17, 134, v17
    v_med3_i32 v17, v17, 0, 3
    v_lshrrev_b32 v19, 7, v18
    v_and_b32 v20, 7, v18
    v_lshl_add_u32 v19, v19, 3, v20
    v_lshrrev_b32 v19, v17, v19
    v_lshl_add_u32 v19, v17, 3, v19
    v_bfe_u32 v20, v18, 3, 4
    v_lshrrev_b32 v21, 4, v19
    v_and_b32 v19, 15, v19
    v_lshl_add_u32 v20, v21, 4, v20
    v_lshl_add_u32 v19, v20, 4, v19
    v_lshlrev_b32 v231, 1, v19
    v_lshlrev_b32 v17, 3, v0
    v_add_u32 v17, 2, v17
    v_cvt_f32_u32 v17, v17
    v_cvt_pk_bf16_f32 v17, v17, v17
    v_lshlrev_b32 v17, 16, v17
    v_cvt_u32_f32 v18, v17
    v_lshrrev_b32 v17, 23, v17
    v_subrev_u32 v17, 134, v17
    v_med3_i32 v17, v17, 0, 3
    v_lshrrev_b32 v19, 7, v18
    v_and_b32 v20, 7, v18
    v_lshl_add_u32 v19, v19, 3, v20
    v_lshrrev_b32 v19, v17, v19
    v_lshl_add_u32 v19, v17, 3, v19
    v_bfe_u32 v20, v18, 3, 4
    v_lshrrev_b32 v21, 4, v19
    v_and_b32 v19, 15, v19
    v_lshl_add_u32 v20, v21, 4, v20
    v_lshl_add_u32 v19, v20, 4, v19
    v_lshlrev_b32 v232, 1, v19
    v_lshlrev_b32 v17, 3, v0
    v_add_u32 v17, 3, v17
    v_cvt_f32_u32 v17, v17
    v_cvt_pk_bf16_f32 v17, v17, v17
    v_lshlrev_b32 v17, 16, v17
    v_cvt_u32_f32 v18, v17
    v_lshrrev_b32 v17, 23, v17
    v_subrev_u32 v17, 134, v17
    v_med3_i32 v17, v17, 0, 3
    v_lshrrev_b32 v19, 7, v18
    v_and_b32 v20, 7, v18
    v_lshl_add_u32 v19, v19, 3, v20
    v_lshrrev_b32 v19, v17, v19
    v_lshl_add_u32 v19, v17, 3, v19
    v_bfe_u32 v20, v18, 3, 4
    v_lshrrev_b32 v21, 4, v19
    v_and_b32 v19, 15, v19
    v_lshl_add_u32 v20, v21, 4, v20
    v_lshl_add_u32 v19, v20, 4, v19
    v_lshlrev_b32 v233, 1, v19
    v_lshlrev_b32 v17, 3, v0
    v_add_u32 v17, 4, v17
    v_cvt_f32_u32 v17, v17
    v_cvt_pk_bf16_f32 v17, v17, v17
    v_lshlrev_b32 v17, 16, v17
    v_cvt_u32_f32 v18, v17
    v_lshrrev_b32 v17, 23, v17
    v_subrev_u32 v17, 134, v17
    v_med3_i32 v17, v17, 0, 3
    v_lshrrev_b32 v19, 7, v18
    v_and_b32 v20, 7, v18
    v_lshl_add_u32 v19, v19, 3, v20
    v_lshrrev_b32 v19, v17, v19
    v_lshl_add_u32 v19, v17, 3, v19
    v_bfe_u32 v20, v18, 3, 4
    v_lshrrev_b32 v21, 4, v19
    v_and_b32 v19, 15, v19
    v_lshl_add_u32 v20, v21, 4, v20
    v_lshl_add_u32 v19, v20, 4, v19
    v_lshlrev_b32 v234, 1, v19
    v_lshlrev_b32 v17, 3, v0
    v_add_u32 v17, 5, v17
    v_cvt_f32_u32 v17, v17
    v_cvt_pk_bf16_f32 v17, v17, v17
    v_lshlrev_b32 v17, 16, v17
    v_cvt_u32_f32 v18, v17
    v_lshrrev_b32 v17, 23, v17
    v_subrev_u32 v17, 134, v17
    v_med3_i32 v17, v17, 0, 3
    v_lshrrev_b32 v19, 7, v18
    v_and_b32 v20, 7, v18
    v_lshl_add_u32 v19, v19, 3, v20
    v_lshrrev_b32 v19, v17, v19
    v_lshl_add_u32 v19, v17, 3, v19
    v_bfe_u32 v20, v18, 3, 4
    v_lshrrev_b32 v21, 4, v19
    v_and_b32 v19, 15, v19
    v_lshl_add_u32 v20, v21, 4, v20
    v_lshl_add_u32 v19, v20, 4, v19
    v_lshlrev_b32 v235, 1, v19
    v_lshlrev_b32 v17, 3, v0
    v_add_u32 v17, 6, v17
    v_cvt_f32_u32 v17, v17
    v_cvt_pk_bf16_f32 v17, v17, v17
    v_lshlrev_b32 v17, 16, v17
    v_cvt_u32_f32 v18, v17
    v_lshrrev_b32 v17, 23, v17
    v_subrev_u32 v17, 134, v17
    v_med3_i32 v17, v17, 0, 3
    v_lshrrev_b32 v19, 7, v18
    v_and_b32 v20, 7, v18
    v_lshl_add_u32 v19, v19, 3, v20
    v_lshrrev_b32 v19, v17, v19
    v_lshl_add_u32 v19, v17, 3, v19
    v_bfe_u32 v20, v18, 3, 4
    v_lshrrev_b32 v21, 4, v19
    v_and_b32 v19, 15, v19
    v_lshl_add_u32 v20, v21, 4, v20
    v_lshl_add_u32 v19, v20, 4, v19
    v_lshlrev_b32 v236, 1, v19
    v_lshlrev_b32 v17, 3, v0
    v_add_u32 v17, 7, v17
    v_cvt_f32_u32 v17, v17
    v_cvt_pk_bf16_f32 v17, v17, v17
    v_lshlrev_b32 v17, 16, v17
    v_cvt_u32_f32 v18, v17
    v_lshrrev_b32 v17, 23, v17
    v_subrev_u32 v17, 134, v17
    v_med3_i32 v17, v17, 0, 3
    v_lshrrev_b32 v19, 7, v18
    v_and_b32 v20, 7, v18
    v_lshl_add_u32 v19, v19, 3, v20
    v_lshrrev_b32 v19, v17, v19
    v_lshl_add_u32 v19, v17, 3, v19
    v_bfe_u32 v20, v18, 3, 4
    v_lshrrev_b32 v21, 4, v19
    v_and_b32 v19, 15, v19
    v_lshl_add_u32 v20, v21, 4, v20
    v_lshl_add_u32 v19, v20, 4, v19
    v_lshlrev_b32 v237, 1, v19
    s_waitcnt vmcnt(0)
    s_mov_b32 s66, 0x3fb8aa3b
    s_mov_b32 s67, 0x32a57060
    s_mov_b32 s68, 0x3f317218
    s_mov_b32 s69, 0x3e22f983
    v_lshlrev_b32 v10, 16, v10
    v_lshlrev_b32 v11, 16, v11
    v_lshlrev_b32 v12, 16, v12
    v_lshlrev_b32 v13, 16, v13
    v_lshlrev_b32 v14, 16, v14
    v_lshlrev_b32 v15, 16, v15
    v_mul_f32 v17, s66, v14
    v_fma_f32 v18, v14, s66, -v17
    v_fmac_f32 v18, s67, v14
    v_exp_f32 v16, v17
    v_mul_f32 v18, s68, v18
    v_fmac_f32 v16, v16, v18
    v_mul_f32 v20, s66, v10
    v_fma_f32 v21, v10, s66, -v20
    v_fmac_f32 v21, s67, v10
    v_exp_f32 v19, v20
    v_mul_f32 v21, s68, v21
    v_fmac_f32 v19, v19, v21
    v_cvt_pk_bf16_f32 v17, v16, v19
    v_lshlrev_b32 v16, 16, v17
    v_and_b32 v19, s72, v17
    v_mul_f32 v19, v19, v16
    v_mul_f32 v19, s66, v19
    v_mul_f32 v20, v11, v16
    v_mul_f32 v20, s69, v20
    v_mul_f32 v22, v12, v16
    v_mul_f32 v23, v13, v16
    v_max_f32 v24, |v22|, |v23|
    s_nop 1
    v_max_f32_dpp v24, v24, v24 quad_perm:[1,0,3,2] row_mask:0xf bank_mask:0xf
    s_nop 1
    v_max_f32_dpp v24, v24, v24 quad_perm:[2,3,0,1] row_mask:0xf bank_mask:0xf
    s_nop 1
    v_max_f32_dpp v24, v24, v24 row_half_mirror row_mask:0xf bank_mask:0xf
    s_nop 1
    v_max_f32_dpp v24, v24, v24 row_mirror row_mask:0xf bank_mask:0xf
    s_nop 1
    v_max_f32_dpp v24, v24, v24 row_bcast:15 row_mask:0xa bank_mask:0xf
    s_nop 1
    v_max_f32_dpp v24, v24, v24 row_bcast:31 row_mask:0xc bank_mask:0xf
    s_nop 0
    v_readlane_b32 s70, v24, 63
    v_mul_f32 v32, 0xbf800000, v19
    v_mul_f32 v36, 0x3f800000, v20
    v_mul_f32 v33, 0xc1000000, v19
    v_mul_f32 v37, 0x41000000, v20
    v_mul_f32 v34, 0xc3000000, v19
    v_mul_f32 v38, 0x43000000, v20
    v_frexp_exp_i32_f32 v24, s70
    v_exp_f32 v32, v32
    v_fract_f32 v36, v36
    v_exp_f32 v33, v33
    v_fract_f32 v37, v37
    v_exp_f32 v34, v34
    v_fract_f32 v38, v38
    v_sub_u32 v25, 0, v24
    v_cos_f32 v40, v36
    v_sin_f32 v44, v36
    v_cos_f32 v41, v37
    v_sin_f32 v45, v37
    v_cos_f32 v42, v38
    v_sin_f32 v46, v38
    v_ldexp_f32 v22, v22, v25
    v_ldexp_f32 v23, v23, v25
    v_mul_f32 v26, v32, v40
    v_mul_f32 v27, v32, v44
    v_mul_f32 v28, v33, v41
    v_mul_f32 v29, v33, v45
    v_mul_f32 v30, v34, v42
    v_mul_f32 v31, v34, v46
    s_mul_i32 s70, s63, 9216
    s_add_u32 s70, s70, s65
    v_lshlrev_b32 v32, 2, v1
    v_add_u32 v32, s70, v32
    v_mul_u32_u24 v33, 288, v6
    v_lshl_add_u32 v33, v7, 4, v33
    v_add_u32 v33, s70, v33
    v_cvt_pk_f16_f32 v38, v22, -v23
    ds_write_b32 v32, v38 offset:0
    v_pk_mul_f32 v[34:35], v[22:23], v[28:29] op_sel:[0,0] op_sel_hi:[0,1]
    v_pk_fma_f32 v[34:35], v[22:23], v[28:29], v[34:35] op_sel:[1,1,0] op_sel_hi:[1,0,1] neg_lo:[1,0,0]
    v_cvt_pk_f16_f32 v38, v34, -v35
    ds_write_b32 v32, v38 offset:288
    v_pk_mul_f32 v[36:37], v[34:35], v[28:29] op_sel:[0,0] op_sel_hi:[0,1]
    v_pk_fma_f32 v[36:37], v[34:35], v[28:29], v[36:37] op_sel:[1,1,0] op_sel_hi:[1,0,1] neg_lo:[1,0,0]
    v_cvt_pk_f16_f32 v38, v36, -v37
    ds_write_b32 v32, v38 offset:576
    v_pk_mul_f32 v[34:35], v[36:37], v[28:29] op_sel:[0,0] op_sel_hi:[0,1]
    v_pk_fma_f32 v[34:35], v[36:37], v[28:29], v[34:35] op_sel:[1,1,0] op_sel_hi:[1,0,1] neg_lo:[1,0,0]
    v_cvt_pk_f16_f32 v38, v34, -v35
    ds_write_b32 v32, v38 offset:864
    v_pk_mul_f32 v[36:37], v[34:35], v[28:29] op_sel:[0,0] op_sel_hi:[0,1]
    v_pk_fma_f32 v[36:37], v[34:35], v[28:29], v[36:37] op_sel:[1,1,0] op_sel_hi:[1,0,1] neg_lo:[1,0,0]
    v_cvt_pk_f16_f32 v38, v36, -v37
    ds_write_b32 v32, v38 offset:1152
    v_pk_mul_f32 v[34:35], v[36:37], v[28:29] op_sel:[0,0] op_sel_hi:[0,1]
    v_pk_fma_f32 v[34:35], v[36:37], v[28:29], v[34:35] op_sel:[1,1,0] op_sel_hi:[1,0,1] neg_lo:[1,0,0]
    v_cvt_pk_f16_f32 v38, v34, -v35
    ds_write_b32 v32, v38 offset:1440
    v_pk_mul_f32 v[36:37], v[34:35], v[28:29] op_sel:[0,0] op_sel_hi:[0,1]
    v_pk_fma_f32 v[36:37], v[34:35], v[28:29], v[36:37] op_sel:[1,1,0] op_sel_hi:[1,0,1] neg_lo:[1,0,0]
    v_cvt_pk_f16_f32 v38, v36, -v37
    ds_write_b32 v32, v38 offset:1728
    v_pk_mul_f32 v[34:35], v[36:37], v[28:29] op_sel:[0,0] op_sel_hi:[0,1]
    v_pk_fma_f32 v[34:35], v[36:37], v[28:29], v[34:35] op_sel:[1,1,0] op_sel_hi:[1,0,1] neg_lo:[1,0,0]
    v_cvt_pk_f16_f32 v38, v34, -v35
    ds_write_b32 v32, v38 offset:2016
    v_pk_mul_f32 v[36:37], v[34:35], v[28:29] op_sel:[0,0] op_sel_hi:[0,1]
    v_pk_fma_f32 v[36:37], v[34:35], v[28:29], v[36:37] op_sel:[1,1,0] op_sel_hi:[1,0,1] neg_lo:[1,0,0]
    v_cvt_pk_f16_f32 v38, v36, -v37
    ds_write_b32 v32, v38 offset:2304
    v_pk_mul_f32 v[34:35], v[36:37], v[28:29] op_sel:[0,0] op_sel_hi:[0,1]
    v_pk_fma_f32 v[34:35], v[36:37], v[28:29], v[34:35] op_sel:[1,1,0] op_sel_hi:[1,0,1] neg_lo:[1,0,0]
    v_cvt_pk_f16_f32 v38, v34, -v35
    ds_write_b32 v32, v38 offset:2592
    v_pk_mul_f32 v[36:37], v[34:35], v[28:29] op_sel:[0,0] op_sel_hi:[0,1]
    v_pk_fma_f32 v[36:37], v[34:35], v[28:29], v[36:37] op_sel:[1,1,0] op_sel_hi:[1,0,1] neg_lo:[1,0,0]
    v_cvt_pk_f16_f32 v38, v36, -v37
    ds_write_b32 v32, v38 offset:2880
    v_pk_mul_f32 v[34:35], v[36:37], v[28:29] op_sel:[0,0] op_sel_hi:[0,1]
    v_pk_fma_f32 v[34:35], v[36:37], v[28:29], v[34:35] op_sel:[1,1,0] op_sel_hi:[1,0,1] neg_lo:[1,0,0]
    v_cvt_pk_f16_f32 v38, v34, -v35
    ds_write_b32 v32, v38 offset:3168
    v_pk_mul_f32 v[36:37], v[34:35], v[28:29] op_sel:[0,0] op_sel_hi:[0,1]
    v_pk_fma_f32 v[36:37], v[34:35], v[28:29], v[36:37] op_sel:[1,1,0] op_sel_hi:[1,0,1] neg_lo:[1,0,0]
    v_cvt_pk_f16_f32 v38, v36, -v37
    ds_write_b32 v32, v38 offset:3456
    v_pk_mul_f32 v[34:35], v[36:37], v[28:29] op_sel:[0,0] op_sel_hi:[0,1]
    v_pk_fma_f32 v[34:35], v[36:37], v[28:29], v[34:35] op_sel:[1,1,0] op_sel_hi:[1,0,1] neg_lo:[1,0,0]
    v_cvt_pk_f16_f32 v38, v34, -v35
    ds_write_b32 v32, v38 offset:3744
    v_pk_mul_f32 v[36:37], v[34:35], v[28:29] op_sel:[0,0] op_sel_hi:[0,1]
    v_pk_fma_f32 v[36:37], v[34:35], v[28:29], v[36:37] op_sel:[1,1,0] op_sel_hi:[1,0,1] neg_lo:[1,0,0]
    v_cvt_pk_f16_f32 v38, v36, -v37
    ds_write_b32 v32, v38 offset:4032
    v_pk_mul_f32 v[34:35], v[36:37], v[28:29] op_sel:[0,0] op_sel_hi:[0,1]
    v_pk_fma_f32 v[34:35], v[36:37], v[28:29], v[34:35] op_sel:[1,1,0] op_sel_hi:[1,0,1] neg_lo:[1,0,0]
    v_cvt_pk_f16_f32 v38, v34, -v35
    ds_write_b32 v32, v38 offset:4320
    ds_read_b128 v[120:123], v33 offset:0
    ds_read_b128 v[124:127], v33 offset:64
    ds_read_b128 v[128:131], v33 offset:128
    ds_read_b128 v[132:135], v33 offset:192
    v_mov_b32 v40, 1.0
    v_mov_b32 v41, 0
    v_mov_b32 v42, v26
    v_mov_b32 v43, v27
    v_pk_mul_f32 v[44:45], v[42:43], v[26:27] op_sel:[0,0] op_sel_hi:[0,1]
    v_pk_fma_f32 v[44:45], v[42:43], v[26:27], v[44:45] op_sel:[1,1,0] op_sel_hi:[1,0,1] neg_lo:[1,0,0]
    v_pk_mul_f32 v[46:47], v[44:45], v[26:27] op_sel:[0,0] op_sel_hi:[0,1]
    v_pk_fma_f32 v[46:47], v[44:45], v[26:27], v[46:47] op_sel:[1,1,0] op_sel_hi:[1,0,1] neg_lo:[1,0,0]
    v_pk_mul_f32 v[48:49], v[46:47], v[26:27] op_sel:[0,0] op_sel_hi:[0,1]
    v_pk_fma_f32 v[48:49], v[46:47], v[26:27], v[48:49] op_sel:[1,1,0] op_sel_hi:[1,0,1] neg_lo:[1,0,0]
    v_pk_mul_f32 v[50:51], v[48:49], v[26:27] op_sel:[0,0] op_sel_hi:[0,1]
    v_pk_fma_f32 v[50:51], v[48:49], v[26:27], v[50:51] op_sel:[1,1,0] op_sel_hi:[1,0,1] neg_lo:[1,0,0]
    v_pk_mul_f32 v[52:53], v[50:51], v[26:27] op_sel:[0,0] op_sel_hi:[0,1]
    v_pk_fma_f32 v[52:53], v[50:51], v[26:27], v[52:53] op_sel:[1,1,0] op_sel_hi:[1,0,1] neg_lo:[1,0,0]
    v_pk_mul_f32 v[54:55], v[52:53], v[26:27] op_sel:[0,0] op_sel_hi:[0,1]
    v_pk_fma_f32 v[54:55], v[52:53], v[26:27], v[54:55] op_sel:[1,1,0] op_sel_hi:[1,0,1] neg_lo:[1,0,0]
    v_mov_b32 v58, v30
    v_mov_b32 v59, v31
    v_pk_mul_f32 v[60:61], v[58:59], v[30:31] op_sel:[0,0] op_sel_hi:[0,1]
    v_pk_fma_f32 v[60:61], v[58:59], v[30:31], v[60:61] op_sel:[1,1,0] op_sel_hi:[1,0,1] neg_lo:[1,0,0]
    v_pk_mul_f32 v[62:63], v[60:61], v[30:31] op_sel:[0,0] op_sel_hi:[0,1]
    v_pk_fma_f32 v[62:63], v[60:61], v[30:31], v[62:63] op_sel:[1,1,0] op_sel_hi:[1,0,1] neg_lo:[1,0,0]
    v_pk_mul_f32 v[64:65], v[62:63], v[30:31] op_sel:[0,0] op_sel_hi:[0,1]
    v_pk_fma_f32 v[64:65], v[62:63], v[30:31], v[64:65] op_sel:[1,1,0] op_sel_hi:[1,0,1] neg_lo:[1,0,0]
    v_pk_mul_f32 v[66:67], v[64:65], v[30:31] op_sel:[0,0] op_sel_hi:[0,1]
    v_pk_fma_f32 v[66:67], v[64:65], v[30:31], v[66:67] op_sel:[1,1,0] op_sel_hi:[1,0,1] neg_lo:[1,0,0]
    v_pk_mul_f32 v[68:69], v[66:67], v[30:31] op_sel:[0,0] op_sel_hi:[0,1]
    v_pk_fma_f32 v[68:69], v[66:67], v[30:31], v[68:69] op_sel:[1,1,0] op_sel_hi:[1,0,1] neg_lo:[1,0,0]
    v_pk_mul_f32 v[70:71], v[68:69], v[30:31] op_sel:[0,0] op_sel_hi:[0,1]
    v_pk_fma_f32 v[70:71], v[68:69], v[30:31], v[70:71] op_sel:[1,1,0] op_sel_hi:[1,0,1] neg_lo:[1,0,0]
    v_pk_mul_f32 v[72:73], v[70:71], v[30:31] op_sel:[0,0] op_sel_hi:[0,1]
    v_pk_fma_f32 v[72:73], v[70:71], v[30:31], v[72:73] op_sel:[1,1,0] op_sel_hi:[1,0,1] neg_lo:[1,0,0]
    v_pk_mul_f32 v[74:75], v[72:73], v[30:31] op_sel:[0,0] op_sel_hi:[0,1]
    v_pk_fma_f32 v[74:75], v[72:73], v[30:31], v[74:75] op_sel:[1,1,0] op_sel_hi:[1,0,1] neg_lo:[1,0,0]
    v_pk_mul_f32 v[76:77], v[74:75], v[30:31] op_sel:[0,0] op_sel_hi:[0,1]
    v_pk_fma_f32 v[76:77], v[74:75], v[30:31], v[76:77] op_sel:[1,1,0] op_sel_hi:[1,0,1] neg_lo:[1,0,0]
    v_pk_mul_f32 v[78:79], v[76:77], v[30:31] op_sel:[0,0] op_sel_hi:[0,1]
    v_pk_fma_f32 v[78:79], v[76:77], v[30:31], v[78:79] op_sel:[1,1,0] op_sel_hi:[1,0,1] neg_lo:[1,0,0]
    v_pk_mul_f32 v[80:81], v[78:79], v[30:31] op_sel:[0,0] op_sel_hi:[0,1]
    v_pk_fma_f32 v[80:81], v[78:79], v[30:31], v[80:81] op_sel:[1,1,0] op_sel_hi:[1,0,1] neg_lo:[1,0,0]
    v_pk_mul_f32 v[82:83], v[80:81], v[30:31] op_sel:[0,0] op_sel_hi:[0,1]
    v_pk_fma_f32 v[82:83], v[80:81], v[30:31], v[82:83] op_sel:[1,1,0] op_sel_hi:[1,0,1] neg_lo:[1,0,0]
    v_pk_mul_f32 v[84:85], v[82:83], v[30:31] op_sel:[0,0] op_sel_hi:[0,1]
    v_pk_fma_f32 v[84:85], v[82:83], v[30:31], v[84:85] op_sel:[1,1,0] op_sel_hi:[1,0,1] neg_lo:[1,0,0]
    v_pk_mul_f32 v[86:87], v[84:85], v[30:31] op_sel:[0,0] op_sel_hi:[0,1]
    v_pk_fma_f32 v[86:87], v[84:85], v[30:31], v[86:87] op_sel:[1,1,0] op_sel_hi:[1,0,1] neg_lo:[1,0,0]
    v_pk_mul_f32 v[88:89], v[86:87], v[30:31] op_sel:[0,0] op_sel_hi:[0,1]
    v_pk_fma_f32 v[88:89], v[86:87], v[30:31], v[88:89] op_sel:[1,1,0] op_sel_hi:[1,0,1] neg_lo:[1,0,0]
    v_mov_b32 v100, 0
    v_mov_b32 v101, 0
    v_mov_b32 v102, 0
    v_mov_b32 v103, 0
    v_mov_b32 v104, 0
    v_mov_b32 v105, 0
    v_mov_b32 v106, 0
    v_mov_b32 v107, 0
    v_mov_b32 v108, 0
    v_mov_b32 v109, 0
    v_mov_b32 v110, 0
    v_mov_b32 v111, 0
    v_cvt_pk_f16_f32 v112, v40, v41
    ds_write_b32 v32, v112 offset:4608
    v_cvt_pk_f16_f32 v113, v42, v43
    ds_write_b32 v32, v113 offset:4896
    v_cvt_pk_f16_f32 v114, v44, v45
    ds_write_b32 v32, v114 offset:5184
    v_cvt_pk_f16_f32 v115, v46, v47
    ds_write_b32 v32, v115 offset:5472
    v_cvt_pk_f16_f32 v112, v48, v49
    ds_write_b32 v32, v112 offset:5760
    v_cvt_pk_f16_f32 v113, v50, v51
    ds_write_b32 v32, v113 offset:6048
    v_cvt_pk_f16_f32 v114, v52, v53
    ds_write_b32 v32, v114 offset:6336
    v_cvt_pk_f16_f32 v115, v54, v55
    ds_write_b32 v32, v115 offset:6624
    v_cvt_pk_f16_f32 v112, v58, v59
    ds_write_b32 v32, v112 offset:6912
    v_pk_mul_f32 v[94:95], v[58:59], v[42:43] op_sel:[0,0] op_sel_hi:[0,1]
    v_pk_fma_f32 v[94:95], v[58:59], v[42:43], v[94:95] op_sel:[1,1,0] op_sel_hi:[1,0,1] neg_lo:[1,0,0]
    v_cvt_pk_f16_f32 v113, v94, v95
    ds_write_b32 v32, v113 offset:7200
    v_pk_mul_f32 v[96:97], v[58:59], v[44:45] op_sel:[0,0] op_sel_hi:[0,1]
    v_pk_fma_f32 v[96:97], v[58:59], v[44:45], v[96:97] op_sel:[1,1,0] op_sel_hi:[1,0,1] neg_lo:[1,0,0]
    v_cvt_pk_f16_f32 v114, v96, v97
    ds_write_b32 v32, v114 offset:7488
    v_pk_mul_f32 v[98:99], v[58:59], v[46:47] op_sel:[0,0] op_sel_hi:[0,1]
    v_pk_fma_f32 v[98:99], v[58:59], v[46:47], v[98:99] op_sel:[1,1,0] op_sel_hi:[1,0,1] neg_lo:[1,0,0]
    v_cvt_pk_f16_f32 v115, v98, v99
    ds_write_b32 v32, v115 offset:7776
    v_pk_mul_f32 v[92:93], v[58:59], v[48:49] op_sel:[0,0] op_sel_hi:[0,1]
    v_pk_fma_f32 v[92:93], v[58:59], v[48:49], v[92:93] op_sel:[1,1,0] op_sel_hi:[1,0,1] neg_lo:[1,0,0]
    v_cvt_pk_f16_f32 v112, v92, v93
    ds_write_b32 v32, v112 offset:8064
    v_pk_mul_f32 v[94:95], v[58:59], v[50:51] op_sel:[0,0] op_sel_hi:[0,1]
    v_pk_fma_f32 v[94:95], v[58:59], v[50:51], v[94:95] op_sel:[1,1,0] op_sel_hi:[1,0,1] neg_lo:[1,0,0]
    v_cvt_pk_f16_f32 v113, v94, v95
    ds_write_b32 v32, v113 offset:8352
    v_pk_mul_f32 v[96:97], v[58:59], v[52:53] op_sel:[0,0] op_sel_hi:[0,1]
    v_pk_fma_f32 v[96:97], v[58:59], v[52:53], v[96:97] op_sel:[1,1,0] op_sel_hi:[1,0,1] neg_lo:[1,0,0]
    v_cvt_pk_f16_f32 v114, v96, v97
    ds_write_b32 v32, v114 offset:8640
    v_pk_mul_f32 v[98:99], v[58:59], v[54:55] op_sel:[0,0] op_sel_hi:[0,1]
    v_pk_fma_f32 v[98:99], v[58:59], v[54:55], v[98:99] op_sel:[1,1,0] op_sel_hi:[1,0,1] neg_lo:[1,0,0]
    v_cvt_pk_f16_f32 v115, v98, v99
    ds_write_b32 v32, v115 offset:8928
    ds_read_b128 v[136:139], v33 offset:4608
    ds_read_b128 v[140:143], v33 offset:4672
    ds_read_b128 v[144:147], v33 offset:4736
    ds_read_b128 v[148:151], v33 offset:4800
    s_waitcnt lgkmcnt(0)
    v_mfma_f32_16x16x32_f16 v[100:103], v[136:139], v[120:123], v[100:103]
    v_mfma_f32_16x16x32_f16 v[100:103], v[140:143], v[124:127], v[100:103]
    v_mfma_f32_16x16x32_f16 v[100:103], v[144:147], v[128:131], v[100:103]
    v_mfma_f32_16x16x32_f16 v[100:103], v[148:151], v[132:135], v[100:103]
    v_cvt_pk_f16_f32 v112, v60, v61
    ds_write_b32 v32, v112 offset:4608
    v_pk_mul_f32 v[94:95], v[60:61], v[44:45] op_sel:[0,0] op_sel_hi:[0,1]
    v_pk_fma_f32 v[94:95], v[60:61], v[44:45], v[94:95] op_sel:[1,1,0] op_sel_hi:[1,0,1] neg_lo:[1,0,0]
    v_cvt_pk_f16_f32 v113, v94, v95
    ds_write_b32 v32, v113 offset:4896
    v_pk_mul_f32 v[96:97], v[60:61], v[48:49] op_sel:[0,0] op_sel_hi:[0,1]
    v_pk_fma_f32 v[96:97], v[60:61], v[48:49], v[96:97] op_sel:[1,1,0] op_sel_hi:[1,0,1] neg_lo:[1,0,0]
    v_cvt_pk_f16_f32 v114, v96, v97
    ds_write_b32 v32, v114 offset:5184
    v_pk_mul_f32 v[98:99], v[60:61], v[52:53] op_sel:[0,0] op_sel_hi:[0,1]
    v_pk_fma_f32 v[98:99], v[60:61], v[52:53], v[98:99] op_sel:[1,1,0] op_sel_hi:[1,0,1] neg_lo:[1,0,0]
    v_cvt_pk_f16_f32 v115, v98, v99
    ds_write_b32 v32, v115 offset:5472
    v_cvt_pk_f16_f32 v112, v62, v63
    ds_write_b32 v32, v112 offset:5760
    v_pk_mul_f32 v[94:95], v[62:63], v[44:45] op_sel:[0,0] op_sel_hi:[0,1]
    v_pk_fma_f32 v[94:95], v[62:63], v[44:45], v[94:95] op_sel:[1,1,0] op_sel_hi:[1,0,1] neg_lo:[1,0,0]
    v_cvt_pk_f16_f32 v113, v94, v95
    ds_write_b32 v32, v113 offset:6048
    v_pk_mul_f32 v[96:97], v[62:63], v[48:49] op_sel:[0,0] op_sel_hi:[0,1]
    v_pk_fma_f32 v[96:97], v[62:63], v[48:49], v[96:97] op_sel:[1,1,0] op_sel_hi:[1,0,1] neg_lo:[1,0,0]
    v_cvt_pk_f16_f32 v114, v96, v97
    ds_write_b32 v32, v114 offset:6336
    v_pk_mul_f32 v[98:99], v[62:63], v[52:53] op_sel:[0,0] op_sel_hi:[0,1]
    v_pk_fma_f32 v[98:99], v[62:63], v[52:53], v[98:99] op_sel:[1,1,0] op_sel_hi:[1,0,1] neg_lo:[1,0,0]
    v_cvt_pk_f16_f32 v115, v98, v99
    ds_write_b32 v32, v115 offset:6624
    v_cvt_pk_f16_f32 v112, v64, v65
    ds_write_b32 v32, v112 offset:6912
    v_pk_mul_f32 v[94:95], v[64:65], v[48:49] op_sel:[0,0] op_sel_hi:[0,1]
    v_pk_fma_f32 v[94:95], v[64:65], v[48:49], v[94:95] op_sel:[1,1,0] op_sel_hi:[1,0,1] neg_lo:[1,0,0]
    v_cvt_pk_f16_f32 v113, v94, v95
    ds_write_b32 v32, v113 offset:7200
    v_cvt_pk_f16_f32 v114, v66, v67
    ds_write_b32 v32, v114 offset:7488
    v_pk_mul_f32 v[98:99], v[66:67], v[48:49] op_sel:[0,0] op_sel_hi:[0,1]
    v_pk_fma_f32 v[98:99], v[66:67], v[48:49], v[98:99] op_sel:[1,1,0] op_sel_hi:[1,0,1] neg_lo:[1,0,0]
    v_cvt_pk_f16_f32 v115, v98, v99
    ds_write_b32 v32, v115 offset:7776
    v_cvt_pk_f16_f32 v112, v68, v69
    ds_write_b32 v32, v112 offset:8064
    v_pk_mul_f32 v[94:95], v[68:69], v[48:49] op_sel:[0,0] op_sel_hi:[0,1]
    v_pk_fma_f32 v[94:95], v[68:69], v[48:49], v[94:95] op_sel:[1,1,0] op_sel_hi:[1,0,1] neg_lo:[1,0,0]
    v_cvt_pk_f16_f32 v113, v94, v95
    ds_write_b32 v32, v113 offset:8352
    v_cvt_pk_f16_f32 v114, v70, v71
    ds_write_b32 v32, v114 offset:8640
    v_pk_mul_f32 v[98:99], v[70:71], v[48:49] op_sel:[0,0] op_sel_hi:[0,1]
    v_pk_fma_f32 v[98:99], v[70:71], v[48:49], v[98:99] op_sel:[1,1,0] op_sel_hi:[1,0,1] neg_lo:[1,0,0]
    v_cvt_pk_f16_f32 v115, v98, v99
    ds_write_b32 v32, v115 offset:8928
    ds_read_b128 v[152:155], v33 offset:4608
    ds_read_b128 v[156:159], v33 offset:4672
    ds_read_b128 v[160:163], v33 offset:4736
    ds_read_b128 v[164:167], v33 offset:4800
    s_waitcnt lgkmcnt(0)
    v_mfma_f32_16x16x32_f16 v[104:107], v[152:155], v[120:123], v[104:107]
    v_mfma_f32_16x16x32_f16 v[104:107], v[156:159], v[124:127], v[104:107]
    v_mfma_f32_16x16x32_f16 v[104:107], v[160:163], v[128:131], v[104:107]
    v_mfma_f32_16x16x32_f16 v[104:107], v[164:167], v[132:135], v[104:107]
    v_cvt_pk_f16_f32 v112, v72, v73
    ds_write_b32 v32, v112 offset:4608
    v_cvt_pk_f16_f32 v113, v74, v75
    ds_write_b32 v32, v113 offset:4896
    v_cvt_pk_f16_f32 v114, v76, v77
    ds_write_b32 v32, v114 offset:5184
    v_cvt_pk_f16_f32 v115, v78, v79
    ds_write_b32 v32, v115 offset:5472
    v_cvt_pk_f16_f32 v112, v80, v81
    ds_write_b32 v32, v112 offset:5760
    v_cvt_pk_f16_f32 v113, v82, v83
    ds_write_b32 v32, v113 offset:6048
    v_cvt_pk_f16_f32 v114, v84, v85
    ds_write_b32 v32, v114 offset:6336
    v_cvt_pk_f16_f32 v115, v86, v87
    ds_write_b32 v32, v115 offset:6624
    v_cvt_pk_f16_f32 v112, v88, v89
    ds_write_b32 v32, v112 offset:6912
    ds_read_b128 v[136:139], v33 offset:4608
    ds_read_b128 v[140:143], v33 offset:4672
    ds_read_b128 v[144:147], v33 offset:4736
    ds_read_b128 v[148:151], v33 offset:4800
    s_waitcnt lgkmcnt(0)
    v_mfma_f32_16x16x32_f16 v[108:111], v[136:139], v[120:123], v[108:111]
    v_mfma_f32_16x16x32_f16 v[108:111], v[140:143], v[124:127], v[108:111]
    v_mfma_f32_16x16x32_f16 v[108:111], v[144:147], v[128:131], v[108:111]
    v_mfma_f32_16x16x32_f16 v[108:111], v[148:151], v[132:135], v[108:111]
    s_lshr_b32 s66, s64, 4
    s_and_b32 s67, s64, 15
    v_lshlrev_b32 v16, 12, v7
    v_lshl_add_u32 v16, v6, 1, v16
    s_mul_i32 s68, s67, 114688
    s_lshl_b32 s69, s66, 5
    s_add_u32 s68, s68, s69
    s_lshl_b32 s69, s63, 16
    s_add_u32 s68, s68, s69
    s_add_u32 s73, s68, 0
    buffer_load_ushort v200, v16, s[36:39], s73 offen offset:0
    buffer_load_ushort v201, v16, s[36:39], s73 offen offset:1024
    buffer_load_ushort v202, v16, s[36:39], s73 offen offset:2048
    buffer_load_ushort v203, v16, s[36:39], s73 offen offset:3072
    s_add_u32 s73, s68, 16384
    buffer_load_ushort v204, v16, s[36:39], s73 offen offset:0
    buffer_load_ushort v205, v16, s[36:39], s73 offen offset:1024
    buffer_load_ushort v206, v16, s[36:39], s73 offen offset:2048
    buffer_load_ushort v207, v16, s[36:39], s73 offen offset:3072
    s_add_u32 s73, s68, 32768
    buffer_load_ushort v208, v16, s[36:39], s73 offen offset:0
    buffer_load_ushort v209, v16, s[36:39], s73 offen offset:1024
    buffer_load_ushort v210, v16, s[36:39], s73 offen offset:2048
    buffer_load_ushort v211, v16, s[36:39], s73 offen offset:3072
    s_add_u32 s73, s68, 49152
    buffer_load_ushort v212, v16, s[36:39], s73 offen offset:0
    buffer_load_ushort v213, v16, s[36:39], s73 offen offset:1024
    buffer_load_ushort v214, v16, s[36:39], s73 offen offset:2048
    buffer_load_ushort v215, v16, s[36:39], s73 offen offset:3072
    s_mul_i32 s70, s63, 3072
    s_add_u32 s70, s70, s65
    v_lshlrev_b32 v34, 6, v6
    v_lshl_add_u32 v34, v7, 4, v34
    v_add_u32 v34, s70, v34
    s_lshl_b32 s70, s63, 2
    s_add_u32 s70, s70, s65
    v_mov_b32 v35, s70
    s_nop 3
    ds_write_b128 v34, v[100:103] offset:18432
    ds_write_b128 v34, v[104:107] offset:19456
    ds_write_b128 v34, v[108:111] offset:20480
    ds_write_b32 v35, v24 offset:26112
    s_waitcnt lgkmcnt(0)
    s_mul_i32 s34, s35, 0x9E3779B1
    s_xor_b32 s34, s34, 0x85EBCA6B
    s_barrier
    v_lshlrev_b32 v34, 4, v0
    v_min_u32 v34, 3056, v34
    v_mov_b32 v35, 0
    ds_read_b128 v[40:43], v34 offset:18432
    ds_read_b128 v[44:47], v34 offset:21504
    ds_read_b64 v[48:49], v35 offset:26112
    ds_read_b128 v[56:59], v34 offset:56832
    ds_read_b128 v[60:63], v34 offset:59904
    ds_read_b64 v[64:65], v35 offset:64512
    v_lshrrev_b32 v36, 1, v34
    s_waitcnt lgkmcnt(0)
    v_max_i32 v50, v48, v49
    v_sub_u32 v48, v48, v50
    v_sub_u32 v49, v49, v50
    v_ldexp_f32 v40, v40, v48
    v_ldexp_f32 v44, v44, v49
    v_ldexp_f32 v41, v41, v48
    v_ldexp_f32 v45, v45, v49
    v_ldexp_f32 v42, v42, v48
    v_ldexp_f32 v46, v46, v49
    v_ldexp_f32 v43, v43, v48
    v_ldexp_f32 v47, v47, v49
    v_add_f32 v40, v40, v44
    v_add_f32 v41, v41, v45
    v_add_f32 v42, v42, v46
    v_add_f32 v43, v43, v47
    v_cvt_pk_f16_f32 v52, v40, v41
    v_cvt_pk_f16_f32 v53, v42, v43
    ds_write_b64 v36, v[52:53] offset:24576
    v_max_i32 v66, v64, v65
    v_sub_u32 v64, v64, v66
    v_sub_u32 v65, v65, v66
    v_ldexp_f32 v56, v56, v64
    v_ldexp_f32 v60, v60, v65
    v_ldexp_f32 v57, v57, v64
    v_ldexp_f32 v61, v61, v65
    v_ldexp_f32 v58, v58, v64
    v_ldexp_f32 v62, v62, v65
    v_ldexp_f32 v59, v59, v64
    v_ldexp_f32 v63, v63, v65
    v_add_f32 v56, v56, v60
    v_add_f32 v57, v57, v61
    v_add_f32 v58, v58, v62
    v_add_f32 v59, v59, v63
    v_cvt_pk_f16_f32 v68, v56, v57
    v_cvt_pk_f16_f32 v69, v58, v59
    ds_write_b64 v36, v[68:69] offset:62976
    s_cmp_eq_u32 s62, 0
    s_cselect_b64 vcc, -1, 0
    s_nop 1
    v_cndmask_b32 v25, v66, v50, vcc
    v_add_u32 v25, 1, v25
    s_waitcnt lgkmcnt(0)
    s_barrier
    ds_read_u16 v40, v230 offset:24576
    ds_read_u16 v41, v231 offset:24576
    ds_read_u16 v42, v232 offset:24576
    ds_read_u16 v43, v233 offset:24576
    ds_read_u16 v44, v234 offset:24576
    ds_read_u16 v45, v235 offset:24576
    ds_read_u16 v46, v236 offset:24576
    ds_read_u16 v47, v237 offset:24576
    ds_read_u16 v48, v230 offset:62976
    ds_read_u16 v49, v231 offset:62976
    ds_read_u16 v50, v232 offset:62976
    ds_read_u16 v51, v233 offset:62976
    ds_read_u16 v52, v234 offset:62976
    ds_read_u16 v53, v235 offset:62976
    ds_read_u16 v54, v236 offset:62976
    ds_read_u16 v55, v237 offset:62976
    v_lshrrev_b32 v34, 2, v0
    v_lshlrev_b32 v34, 5, v34
    v_bfe_u32 v35, v0, 1, 1
    v_mul_u32_u24 v35, 2560, v35
    v_and_b32 v36, 1, v0
    v_lshl_add_u32 v34, v36, 4, v34
    v_add_u32 v34, v34, v35
    v_bfe_u32 v35, v0, 5, 1
    v_mul_u32_u24 v35, 2560, v35
    v_and_b32 v36, 31, v0
    v_lshl_add_u32 v35, v36, 4, v35
    v_bfe_u32 v36, v0, 6, 1
    v_mul_u32_u24 v36, 38400, v36
    v_add_u32 v35, v35, v36
    v_mov_b32 v64, 0
    v_mov_b32 v65, 0
    v_mov_b32 v66, 0
    v_mov_b32 v67, 0
    ds_write_b128 v35, v[64:67] offset:33280
    s_waitcnt lgkmcnt(1)
    v_lshl_or_b32 v56, v41, 16, v40
    v_lshl_or_b32 v57, v43, 16, v42
    v_lshl_or_b32 v58, v45, 16, v44
    v_lshl_or_b32 v59, v47, 16, v46
    ds_write_b128 v34, v[56:59] offset:33792
    v_lshl_or_b32 v60, v49, 16, v48
    v_lshl_or_b32 v61, v51, 16, v50
    v_lshl_or_b32 v62, v53, 16, v52
    v_lshl_or_b32 v63, v55, 16, v54
    v_add_u32 v37, 38400, v34
    ds_write_b128 v37, v[60:63] offset:33792
    s_waitcnt vmcnt(0) lgkmcnt(0)
    s_lshr_b32 s66, s64, 4
    s_and_b32 s67, s64, 15
    v_lshl_or_b32 v216, v201, 16, v200
    v_lshl_or_b32 v217, v203, 16, v202
    v_lshl_or_b32 v218, v205, 16, v204
    v_lshl_or_b32 v219, v207, 16, v206
    v_lshl_or_b32 v220, v209, 16, v208
    v_lshl_or_b32 v221, v211, 16, v210
    v_lshl_or_b32 v222, v213, 16, v212
    v_lshl_or_b32 v223, v215, 16, v214
    s_lshr_b32 s68, s66, 2
    s_lshl_b32 s68, s68, 4
    s_add_u32 s68, s68, s67
    s_mul_i32 s68, s68, 14336
    s_and_b32 s69, s66, 3
    s_lshl_b32 s70, s69, 10
    s_add_u32 s70, s70, s68
    s_lshl_b32 s71, s63, 13
    s_add_u32 s70, s70, s71
    buffer_store_dwordx4 v[216:219], v2, s[40:43], s70 offen sc1
    s_cmp_eq_u32 s63, 0
    s_cbranch_scc0 FC_RP1
    s_add_u32 s70, s70, 4096
    buffer_store_dwordx4 v[220:223], v2, s[40:43], s70 offen sc1
    s_branch FC_RPJ
FC_RP1:
    s_lshl_b32 s70, s69, 9
    s_add_u32 s70, s70, s68
    s_add_u32 s70, s70, 12288
    v_lshlrev_b32 v17, 3, v1
    buffer_store_dwordx2 v[220:221], v17, s[40:43], s70 offen sc1
FC_RPJ:
    s_cmp_eq_u32 s60, 0
    s_cbranch_scc0 FC_W1
    v_lshlrev_b32 v34, 2, v1
    s_mov_b32 s76, 1048576
    s_mov_b64 s[74:75], -1
POLL_FC_8:
    buffer_load_dword v36, v34, s[52:55], 0 offen offset:0 sc1
    buffer_load_dword v37, v34, s[52:55], 0 offen offset:256 sc1
    buffer_load_dword v38, v34, s[52:55], 0 offen offset:512 sc1
    buffer_load_dword v39, v34, s[52:55], 0 offen offset:768 sc1
    s_waitcnt vmcnt(0)
    v_xor_b32 v37, s34, v37
    v_xor_b32 v38, s34, v38
    v_xor_b32 v39, s34, v39
    v_xor_b32 v36, s34, v36
    v_or_b32 v36, v36, v37
    v_or_b32 v36, v36, v38
    v_or_b32 v36, v36, v39
    v_cmp_ne_u32 vcc, 0, v36
    s_and_b64 vcc, vcc, s[74:75]
    s_cbranch_scc0 POLL_FC_8_D
    s_sleep 8
    s_sub_u32 s76, s76, 1
    s_cmp_lg_u32 s76, 0
    s_cbranch_scc1 POLL_FC_8
POLL_FC_8_D:
FC_W1:
    s_waitcnt vmcnt(0)
    s_barrier
    s_cmp_eq_u32 s60, 0
    s_cbranch_scc0 FC_RF2
    s_lshl_b32 s70, s61, 2
    s_add_u32 s70, s70, 4096
    v_mov_b32 v36, 0
    v_mov_b32 v37, s34
    s_mov_b64 exec, 1
    buffer_store_dword v37, v36, s[52:55], s70 offen sc1
    s_mov_b64 exec, -1
FC_RF2:
    s_lshl_b32 s70, s63, 7
    v_add_u32 v34, s70, v1
    v_sub_u32 v35, 255, v34
    v_lshlrev_b32 v35, 13, v35
    s_lshl_b32 s70, s64, 4
    v_add_u32 v35, s70, v35
    v_subrev_u32 v36, 0x2000, v35
    v_subrev_u32 v37, 0x80000, v35
    v_subrev_u32 v38, 0x82000, v35
    buffer_load_dwordx4 v[168:171], v35, s[44:47], 0 offen
    buffer_load_dwordx4 v[172:175], v36, s[44:47], 0 offen
    buffer_load_dwordx4 v[176:179], v37, s[44:47], 0 offen
    buffer_load_dwordx4 v[180:183], v38, s[44:47], 0 offen
    s_lshl_b32 s70, s63, 7
    v_add_u32 v34, s70, v1
    v_lshlrev_b32 v34, 4, v34
    v_add_u32 v34, s65, v34
    v_lshrrev_b32 v35, 2, v1
    v_mul_u32_u24 v35, 4160, v35
    v_and_b32 v36, 3, v1
    v_lshl_add_u32 v35, v36, 4, v35
    s_mul_i32 s70, s63, 16640
    s_add_u32 s70, s70, s65
    v_add_u32 v35, s70, v35
    v_mov_b32 v88, 0
    v_mov_b32 v89, 0
    v_mov_b32 v90, 0
    v_mov_b32 v91, 0
    s_mov_b64 exec, 0xffff
    ds_write_b128 v35, v[88:91] offset:4096
    s_mov_b64 exec, -1
    v_and_b32 v35, 3, v6
    v_sub_u32 v35, 7, v35
    v_mul_u32_u24 v35, 4160, v35
    v_lshrrev_b32 v36, 2, v6
    v_sub_u32 v36, v7, v36
    v_lshl_add_u32 v35, v36, 4, v35
    s_lshl_b32 s70, s63, 6
    s_sub_u32 s70, s65, s70
    s_add_u32 s70, s70, 112
    v_add_u32 v12, s70, v35
    v_subrev_u32 v13, 16640, v12
    v_lshrrev_b32 v35, 1, v7
    v_mul_u32_u24 v35, 2560, v35
    v_lshl_add_u32 v35, v6, 5, v35
    v_and_b32 v36, 1, v7
    v_lshl_add_u32 v35, v36, 4, v35
    s_lshl_b32 s70, s63, 5
    s_sub_u32 s70, s65, s70
    s_add_u32 s70, s70, 33312
    v_add_u32 v14, s70, v35
    s_waitcnt vmcnt(2)
    v_alignbit_b32 v48, v169, v168, 16
    v_alignbit_b32 v49, v170, v169, 16
    v_alignbit_b32 v50, v171, v170, 16
    v_alignbit_b32 v51, v172, v171, 16
    v_alignbit_b32 v52, v173, v172, 16
    v_alignbit_b32 v53, v174, v173, 16
    v_alignbit_b32 v54, v175, v174, 16
    ds_write_b128 v34, v[168:171] offset:0
    ds_write_b128 v34, v[170:173] offset:16640
    ds_write_b128 v34, v[48:51] offset:4160
    ds_write_b128 v34, v[50:53] offset:20800
    v_pk_mov_b32 v[92:93], v[168:169], v[170:171] op_sel:[1,0]
    v_pk_mov_b32 v[94:95], v[170:171], v[172:173] op_sel:[1,0]
    ds_write_b128 v34, v[92:95] offset:8320
    v_pk_mov_b32 v[96:97], v[170:171], v[172:173] op_sel:[1,0]
    v_pk_mov_b32 v[98:99], v[172:173], v[174:175] op_sel:[1,0]
    ds_write_b128 v34, v[96:99] offset:24960
    v_pk_mov_b32 v[100:101], v[48:49], v[50:51] op_sel:[1,0]
    v_pk_mov_b32 v[102:103], v[50:51], v[52:53] op_sel:[1,0]
    ds_write_b128 v34, v[100:103] offset:12480
    v_pk_mov_b32 v[104:105], v[50:51], v[52:53] op_sel:[1,0]
    v_pk_mov_b32 v[106:107], v[52:53], v[54:55] op_sel:[1,0]
    ds_write_b128 v34, v[104:107] offset:29120
    s_waitcnt vmcnt(0)
    v_alignbit_b32 v72, v177, v176, 16
    v_alignbit_b32 v73, v178, v177, 16
    v_alignbit_b32 v74, v179, v178, 16
    v_alignbit_b32 v75, v180, v179, 16
    v_alignbit_b32 v76, v181, v180, 16
    v_alignbit_b32 v77, v182, v181, 16
    v_alignbit_b32 v78, v183, v182, 16
    ds_write_b128 v34, v[176:179] offset:1024
    ds_write_b128 v34, v[178:181] offset:17664
    ds_write_b128 v34, v[72:75] offset:5184
    ds_write_b128 v34, v[74:77] offset:21824
    v_pk_mov_b32 v[108:109], v[176:177], v[178:179] op_sel:[1,0]
    v_pk_mov_b32 v[110:111], v[178:179], v[180:181] op_sel:[1,0]
    ds_write_b128 v34, v[108:111] offset:9344
    v_pk_mov_b32 v[112:113], v[178:179], v[180:181] op_sel:[1,0]
    v_pk_mov_b32 v[114:115], v[180:181], v[182:183] op_sel:[1,0]
    ds_write_b128 v34, v[112:115] offset:25984
    v_pk_mov_b32 v[116:117], v[72:73], v[74:75] op_sel:[1,0]
    v_pk_mov_b32 v[118:119], v[74:75], v[76:77] op_sel:[1,0]
    ds_write_b128 v34, v[116:119] offset:13504
    v_pk_mov_b32 v[120:121], v[74:75], v[76:77] op_sel:[1,0]
    v_pk_mov_b32 v[122:123], v[76:77], v[78:79] op_sel:[1,0]
    ds_write_b128 v34, v[120:123] offset:30144
    v_mov_b32 v10, v25
    v_mov_b32 v11, v15
    v_mov_b32 v16, 0
    v_mov_b32 v17, 0
    v_mov_b32 v18, 0
    v_mov_b32 v19, 0
    v_mov_b32 v20, 0
    v_mov_b32 v21, 0
    v_mov_b32 v22, 0
    v_mov_b32 v23, 0
    v_mov_b32 v24, 0
    v_mov_b32 v25, 0
    v_mov_b32 v26, 0
    v_mov_b32 v27, 0
    v_mov_b32 v28, 0
    v_mov_b32 v29, 0
    v_mov_b32 v30, 0
    v_mov_b32 v31, 0
    v_mov_b32 v32, 0
    v_mov_b32 v33, 0
    v_mov_b32 v34, 0
    v_mov_b32 v35, 0
    v_mov_b32 v36, 0
    v_mov_b32 v37, 0
    v_mov_b32 v38, 0
    v_mov_b32 v39, 0
    v_mov_b32 v40, 0
    v_mov_b32 v41, 0
    v_mov_b32 v42, 0
    v_mov_b32 v43, 0
    v_mov_b32 v44, 0
    v_mov_b32 v45, 0
    v_mov_b32 v46, 0
    v_mov_b32 v47, 0
    s_waitcnt vmcnt(0) lgkmcnt(0)
    s_barrier
    s_cmp_eq_u32 s60, 0
    s_cbranch_scc0 FC_RF
FC_RF:
    ds_read_b128 v[48:51], v12 offset:3968
    ds_read_b128 v[52:55], v13 offset:3968
    ds_read_b128 v[56:59], v14 offset:480
    ds_read_b128 v[60:63], v14 offset:992
    ds_read_b128 v[64:67], v14 offset:1504
    ds_read_b128 v[68:71], v14 offset:2016
    ds_read_b128 v[72:75], v12 offset:3840
    ds_read_b128 v[76:79], v13 offset:3840
    ds_read_b128 v[80:83], v14 offset:416
    ds_read_b128 v[84:87], v14 offset:928
    ds_read_b128 v[88:91], v14 offset:1440
    ds_read_b128 v[92:95], v14 offset:1952
    s_waitcnt lgkmcnt(6)
    v_mfma_f32_16x16x32_f16 v[16:19], v[48:51], v[56:59], v[16:19]
    ds_read_b128 v[96:99], v12 offset:3712
    v_mfma_f32_16x16x32_f16 v[20:23], v[52:55], v[56:59], v[20:23]
    ds_read_b128 v[100:103], v13 offset:3712
    v_mfma_f32_16x16x32_f16 v[24:27], v[48:51], v[60:63], v[24:27]
    ds_read_b128 v[104:107], v14 offset:352
    v_mfma_f32_16x16x32_f16 v[28:31], v[52:55], v[60:63], v[28:31]
    ds_read_b128 v[108:111], v14 offset:864
    v_mfma_f32_16x16x32_f16 v[32:35], v[48:51], v[64:67], v[32:35]
    ds_read_b128 v[112:115], v14 offset:1376
    v_mfma_f32_16x16x32_f16 v[36:39], v[52:55], v[64:67], v[36:39]
    ds_read_b128 v[116:119], v14 offset:1888
    v_mfma_f32_16x16x32_f16 v[40:43], v[48:51], v[68:71], v[40:43]
    v_mfma_f32_16x16x32_f16 v[44:47], v[52:55], v[68:71], v[44:47]
    s_waitcnt lgkmcnt(6)
    v_mfma_f32_16x16x32_f16 v[16:19], v[72:75], v[80:83], v[16:19]
    ds_read_b128 v[48:51], v12 offset:3584
    v_mfma_f32_16x16x32_f16 v[20:23], v[76:79], v[80:83], v[20:23]
    ds_read_b128 v[52:55], v13 offset:3584
    v_mfma_f32_16x16x32_f16 v[24:27], v[72:75], v[84:87], v[24:27]
    ds_read_b128 v[56:59], v14 offset:288
    v_mfma_f32_16x16x32_f16 v[28:31], v[76:79], v[84:87], v[28:31]
    ds_read_b128 v[60:63], v14 offset:800
    v_mfma_f32_16x16x32_f16 v[32:35], v[72:75], v[88:91], v[32:35]
    ds_read_b128 v[64:67], v14 offset:1312
    v_mfma_f32_16x16x32_f16 v[36:39], v[76:79], v[88:91], v[36:39]
    ds_read_b128 v[68:71], v14 offset:1824
    v_mfma_f32_16x16x32_f16 v[40:43], v[72:75], v[92:95], v[40:43]
    v_mfma_f32_16x16x32_f16 v[44:47], v[76:79], v[92:95], v[44:47]
    s_waitcnt lgkmcnt(6)
    v_mfma_f32_16x16x32_f16 v[16:19], v[96:99], v[104:107], v[16:19]
    ds_read_b128 v[72:75], v12 offset:3456
    v_mfma_f32_16x16x32_f16 v[20:23], v[100:103], v[104:107], v[20:23]
    ds_read_b128 v[76:79], v13 offset:3456
    v_mfma_f32_16x16x32_f16 v[24:27], v[96:99], v[108:111], v[24:27]
    ds_read_b128 v[80:83], v14 offset:224
    v_mfma_f32_16x16x32_f16 v[28:31], v[100:103], v[108:111], v[28:31]
    ds_read_b128 v[84:87], v14 offset:736
    v_mfma_f32_16x16x32_f16 v[32:35], v[96:99], v[112:115], v[32:35]
    ds_read_b128 v[88:91], v14 offset:1248
    v_mfma_f32_16x16x32_f16 v[36:39], v[100:103], v[112:115], v[36:39]
    ds_read_b128 v[92:95], v14 offset:1760
    v_mfma_f32_16x16x32_f16 v[40:43], v[96:99], v[116:119], v[40:43]
    v_mfma_f32_16x16x32_f16 v[44:47], v[100:103], v[116:119], v[44:47]
    s_waitcnt lgkmcnt(6)
    v_mfma_f32_16x16x32_f16 v[16:19], v[48:51], v[56:59], v[16:19]
    ds_read_b128 v[96:99], v12 offset:3328
    v_mfma_f32_16x16x32_f16 v[20:23], v[52:55], v[56:59], v[20:23]
    ds_read_b128 v[100:103], v13 offset:3328
    v_mfma_f32_16x16x32_f16 v[24:27], v[48:51], v[60:63], v[24:27]
    ds_read_b128 v[104:107], v14 offset:160
    v_mfma_f32_16x16x32_f16 v[28:31], v[52:55], v[60:63], v[28:31]
    ds_read_b128 v[108:111], v14 offset:672
    v_mfma_f32_16x16x32_f16 v[32:35], v[48:51], v[64:67], v[32:35]
    ds_read_b128 v[112:115], v14 offset:1184
    v_mfma_f32_16x16x32_f16 v[36:39], v[52:55], v[64:67], v[36:39]
    ds_read_b128 v[116:119], v14 offset:1696
    v_mfma_f32_16x16x32_f16 v[40:43], v[48:51], v[68:71], v[40:43]
    v_mfma_f32_16x16x32_f16 v[44:47], v[52:55], v[68:71], v[44:47]
    s_waitcnt lgkmcnt(6)
    v_mfma_f32_16x16x32_f16 v[16:19], v[72:75], v[80:83], v[16:19]
    ds_read_b128 v[48:51], v12 offset:3200
    v_mfma_f32_16x16x32_f16 v[20:23], v[76:79], v[80:83], v[20:23]
    ds_read_b128 v[52:55], v13 offset:3200
    v_mfma_f32_16x16x32_f16 v[24:27], v[72:75], v[84:87], v[24:27]
    ds_read_b128 v[56:59], v14 offset:96
    v_mfma_f32_16x16x32_f16 v[28:31], v[76:79], v[84:87], v[28:31]
    ds_read_b128 v[60:63], v14 offset:608
    v_mfma_f32_16x16x32_f16 v[32:35], v[72:75], v[88:91], v[32:35]
    ds_read_b128 v[64:67], v14 offset:1120
    v_mfma_f32_16x16x32_f16 v[36:39], v[76:79], v[88:91], v[36:39]
    ds_read_b128 v[68:71], v14 offset:1632
    v_mfma_f32_16x16x32_f16 v[40:43], v[72:75], v[92:95], v[40:43]
    v_mfma_f32_16x16x32_f16 v[44:47], v[76:79], v[92:95], v[44:47]
    s_waitcnt lgkmcnt(6)
    v_mfma_f32_16x16x32_f16 v[16:19], v[96:99], v[104:107], v[16:19]
    ds_read_b128 v[72:75], v12 offset:3072
    v_mfma_f32_16x16x32_f16 v[20:23], v[100:103], v[104:107], v[20:23]
    ds_read_b128 v[76:79], v13 offset:3072
    v_mfma_f32_16x16x32_f16 v[24:27], v[96:99], v[108:111], v[24:27]
    ds_read_b128 v[80:83], v14 offset:32
    v_mfma_f32_16x16x32_f16 v[28:31], v[100:103], v[108:111], v[28:31]
    ds_read_b128 v[84:87], v14 offset:544
    v_mfma_f32_16x16x32_f16 v[32:35], v[96:99], v[112:115], v[32:35]
    ds_read_b128 v[88:91], v14 offset:1056
    v_mfma_f32_16x16x32_f16 v[36:39], v[100:103], v[112:115], v[36:39]
    ds_read_b128 v[92:95], v14 offset:1568
    v_mfma_f32_16x16x32_f16 v[40:43], v[96:99], v[116:119], v[40:43]
    v_mfma_f32_16x16x32_f16 v[44:47], v[100:103], v[116:119], v[44:47]
    s_waitcnt lgkmcnt(6)
    v_mfma_f32_16x16x32_f16 v[16:19], v[48:51], v[56:59], v[16:19]
    ds_read_b128 v[96:99], v12 offset:2944
    v_mfma_f32_16x16x32_f16 v[20:23], v[52:55], v[56:59], v[20:23]
    ds_read_b128 v[100:103], v13 offset:2944
    v_mfma_f32_16x16x32_f16 v[24:27], v[48:51], v[60:63], v[24:27]
    ds_read_b128 v[108:111], v14 offset:480
    v_mfma_f32_16x16x32_f16 v[28:31], v[52:55], v[60:63], v[28:31]
    ds_read_b128 v[112:115], v14 offset:992
    v_mfma_f32_16x16x32_f16 v[32:35], v[48:51], v[64:67], v[32:35]
    ds_read_b128 v[116:119], v14 offset:1504
    v_mfma_f32_16x16x32_f16 v[36:39], v[52:55], v[64:67], v[36:39]
    v_mfma_f32_16x16x32_f16 v[40:43], v[48:51], v[68:71], v[40:43]
    v_mfma_f32_16x16x32_f16 v[44:47], v[52:55], v[68:71], v[44:47]
    s_waitcnt lgkmcnt(5)
    v_mfma_f32_16x16x32_f16 v[16:19], v[72:75], v[80:83], v[16:19]
    ds_read_b128 v[48:51], v12 offset:2816
    v_mfma_f32_16x16x32_f16 v[20:23], v[76:79], v[80:83], v[20:23]
    ds_read_b128 v[52:55], v13 offset:2816
    v_mfma_f32_16x16x32_f16 v[24:27], v[72:75], v[84:87], v[24:27]
    ds_read_b128 v[60:63], v14 offset:416
    v_mfma_f32_16x16x32_f16 v[28:31], v[76:79], v[84:87], v[28:31]
    ds_read_b128 v[64:67], v14 offset:928
    v_mfma_f32_16x16x32_f16 v[32:35], v[72:75], v[88:91], v[32:35]
    ds_read_b128 v[68:71], v14 offset:1440
    v_mfma_f32_16x16x32_f16 v[36:39], v[76:79], v[88:91], v[36:39]
    v_mfma_f32_16x16x32_f16 v[40:43], v[72:75], v[92:95], v[40:43]
    v_mfma_f32_16x16x32_f16 v[44:47], v[76:79], v[92:95], v[44:47]
    s_waitcnt lgkmcnt(5)
    v_mfma_f32_16x16x32_f16 v[24:27], v[96:99], v[108:111], v[24:27]
    ds_read_b128 v[72:75], v12 offset:2688
    v_mfma_f32_16x16x32_f16 v[28:31], v[100:103], v[108:111], v[28:31]
    ds_read_b128 v[76:79], v13 offset:2688
    v_mfma_f32_16x16x32_f16 v[32:35], v[96:99], v[112:115], v[32:35]
    ds_read_b128 v[84:87], v14 offset:352
    v_mfma_f32_16x16x32_f16 v[36:39], v[100:103], v[112:115], v[36:39]
    ds_read_b128 v[88:91], v14 offset:864
    v_mfma_f32_16x16x32_f16 v[40:43], v[96:99], v[116:119], v[40:43]
    ds_read_b128 v[92:95], v14 offset:1376
    v_mfma_f32_16x16x32_f16 v[44:47], v[100:103], v[116:119], v[44:47]
    s_waitcnt lgkmcnt(5)
    v_mfma_f32_16x16x32_f16 v[24:27], v[48:51], v[60:63], v[24:27]
    ds_read_b128 v[96:99], v12 offset:2560
    v_mfma_f32_16x16x32_f16 v[28:31], v[52:55], v[60:63], v[28:31]
    ds_read_b128 v[100:103], v13 offset:2560
    v_mfma_f32_16x16x32_f16 v[32:35], v[48:51], v[64:67], v[32:35]
    ds_read_b128 v[108:111], v14 offset:288
    v_mfma_f32_16x16x32_f16 v[36:39], v[52:55], v[64:67], v[36:39]
    ds_read_b128 v[112:115], v14 offset:800
    v_mfma_f32_16x16x32_f16 v[40:43], v[48:51], v[68:71], v[40:43]
    ds_read_b128 v[116:119], v14 offset:1312
    v_mfma_f32_16x16x32_f16 v[44:47], v[52:55], v[68:71], v[44:47]
    s_waitcnt lgkmcnt(5)
    v_mfma_f32_16x16x32_f16 v[24:27], v[72:75], v[84:87], v[24:27]
    ds_read_b128 v[48:51], v12 offset:2432
    v_mfma_f32_16x16x32_f16 v[28:31], v[76:79], v[84:87], v[28:31]
    ds_read_b128 v[52:55], v13 offset:2432
    v_mfma_f32_16x16x32_f16 v[32:35], v[72:75], v[88:91], v[32:35]
    ds_read_b128 v[60:63], v14 offset:224
    v_mfma_f32_16x16x32_f16 v[36:39], v[76:79], v[88:91], v[36:39]
    ds_read_b128 v[64:67], v14 offset:736
    v_mfma_f32_16x16x32_f16 v[40:43], v[72:75], v[92:95], v[40:43]
    ds_read_b128 v[68:71], v14 offset:1248
    v_mfma_f32_16x16x32_f16 v[44:47], v[76:79], v[92:95], v[44:47]
    s_waitcnt lgkmcnt(5)
    v_mfma_f32_16x16x32_f16 v[24:27], v[96:99], v[108:111], v[24:27]
    ds_read_b128 v[72:75], v12 offset:2304
    v_mfma_f32_16x16x32_f16 v[28:31], v[100:103], v[108:111], v[28:31]
    ds_read_b128 v[76:79], v13 offset:2304
    v_mfma_f32_16x16x32_f16 v[32:35], v[96:99], v[112:115], v[32:35]
    ds_read_b128 v[84:87], v14 offset:160
    v_mfma_f32_16x16x32_f16 v[36:39], v[100:103], v[112:115], v[36:39]
    ds_read_b128 v[88:91], v14 offset:672
    v_mfma_f32_16x16x32_f16 v[40:43], v[96:99], v[116:119], v[40:43]
    ds_read_b128 v[92:95], v14 offset:1184
    v_mfma_f32_16x16x32_f16 v[44:47], v[100:103], v[116:119], v[44:47]
    s_waitcnt lgkmcnt(5)
    v_mfma_f32_16x16x32_f16 v[24:27], v[48:51], v[60:63], v[24:27]
    ds_read_b128 v[96:99], v12 offset:2176
    v_mfma_f32_16x16x32_f16 v[28:31], v[52:55], v[60:63], v[28:31]
    ds_read_b128 v[100:103], v13 offset:2176
    v_mfma_f32_16x16x32_f16 v[32:35], v[48:51], v[64:67], v[32:35]
    ds_read_b128 v[108:111], v14 offset:96
    v_mfma_f32_16x16x32_f16 v[36:39], v[52:55], v[64:67], v[36:39]
    ds_read_b128 v[112:115], v14 offset:608
    v_mfma_f32_16x16x32_f16 v[40:43], v[48:51], v[68:71], v[40:43]
    ds_read_b128 v[116:119], v14 offset:1120
    v_mfma_f32_16x16x32_f16 v[44:47], v[52:55], v[68:71], v[44:47]
    s_waitcnt lgkmcnt(5)
    v_mfma_f32_16x16x32_f16 v[24:27], v[72:75], v[84:87], v[24:27]
    ds_read_b128 v[48:51], v12 offset:2048
    v_mfma_f32_16x16x32_f16 v[28:31], v[76:79], v[84:87], v[28:31]
    ds_read_b128 v[52:55], v13 offset:2048
    v_mfma_f32_16x16x32_f16 v[32:35], v[72:75], v[88:91], v[32:35]
    ds_read_b128 v[60:63], v14 offset:32
    v_mfma_f32_16x16x32_f16 v[36:39], v[76:79], v[88:91], v[36:39]
    ds_read_b128 v[64:67], v14 offset:544
    v_mfma_f32_16x16x32_f16 v[40:43], v[72:75], v[92:95], v[40:43]
    ds_read_b128 v[68:71], v14 offset:1056
    v_mfma_f32_16x16x32_f16 v[44:47], v[76:79], v[92:95], v[44:47]
    s_waitcnt lgkmcnt(5)
    v_mfma_f32_16x16x32_f16 v[24:27], v[96:99], v[108:111], v[24:27]
    ds_read_b128 v[72:75], v12 offset:1920
    v_mfma_f32_16x16x32_f16 v[28:31], v[100:103], v[108:111], v[28:31]
    ds_read_b128 v[76:79], v13 offset:1920
    v_mfma_f32_16x16x32_f16 v[32:35], v[96:99], v[112:115], v[32:35]
    ds_read_b128 v[88:91], v14 offset:480
    v_mfma_f32_16x16x32_f16 v[36:39], v[100:103], v[112:115], v[36:39]
    ds_read_b128 v[92:95], v14 offset:992
    v_mfma_f32_16x16x32_f16 v[40:43], v[96:99], v[116:119], v[40:43]
    v_mfma_f32_16x16x32_f16 v[44:47], v[100:103], v[116:119], v[44:47]
    s_waitcnt lgkmcnt(4)
    v_mfma_f32_16x16x32_f16 v[24:27], v[48:51], v[60:63], v[24:27]
    ds_read_b128 v[96:99], v12 offset:1792
    v_mfma_f32_16x16x32_f16 v[28:31], v[52:55], v[60:63], v[28:31]
    ds_read_b128 v[100:103], v13 offset:1792
    v_mfma_f32_16x16x32_f16 v[32:35], v[48:51], v[64:67], v[32:35]
    ds_read_b128 v[112:115], v14 offset:416
    v_mfma_f32_16x16x32_f16 v[36:39], v[52:55], v[64:67], v[36:39]
    ds_read_b128 v[116:119], v14 offset:928
    v_mfma_f32_16x16x32_f16 v[40:43], v[48:51], v[68:71], v[40:43]
    v_mfma_f32_16x16x32_f16 v[44:47], v[52:55], v[68:71], v[44:47]
    s_waitcnt lgkmcnt(4)
    v_mfma_f32_16x16x32_f16 v[32:35], v[72:75], v[88:91], v[32:35]
    ds_read_b128 v[48:51], v12 offset:1664
    v_mfma_f32_16x16x32_f16 v[36:39], v[76:79], v[88:91], v[36:39]
    ds_read_b128 v[52:55], v13 offset:1664
    v_mfma_f32_16x16x32_f16 v[40:43], v[72:75], v[92:95], v[40:43]
    ds_read_b128 v[64:67], v14 offset:352
    v_mfma_f32_16x16x32_f16 v[44:47], v[76:79], v[92:95], v[44:47]
    ds_read_b128 v[68:71], v14 offset:864
    s_waitcnt lgkmcnt(4)
    v_mfma_f32_16x16x32_f16 v[32:35], v[96:99], v[112:115], v[32:35]
    ds_read_b128 v[72:75], v12 offset:1536
    v_mfma_f32_16x16x32_f16 v[36:39], v[100:103], v[112:115], v[36:39]
    ds_read_b128 v[76:79], v13 offset:1536
    v_mfma_f32_16x16x32_f16 v[40:43], v[96:99], v[116:119], v[40:43]
    ds_read_b128 v[88:91], v14 offset:288
    v_mfma_f32_16x16x32_f16 v[44:47], v[100:103], v[116:119], v[44:47]
    ds_read_b128 v[92:95], v14 offset:800
    s_waitcnt lgkmcnt(4)
    v_mfma_f32_16x16x32_f16 v[32:35], v[48:51], v[64:67], v[32:35]
    ds_read_b128 v[96:99], v12 offset:1408
    v_mfma_f32_16x16x32_f16 v[36:39], v[52:55], v[64:67], v[36:39]
    ds_read_b128 v[100:103], v13 offset:1408
    v_mfma_f32_16x16x32_f16 v[40:43], v[48:51], v[68:71], v[40:43]
    ds_read_b128 v[112:115], v14 offset:224
    v_mfma_f32_16x16x32_f16 v[44:47], v[52:55], v[68:71], v[44:47]
    ds_read_b128 v[116:119], v14 offset:736
    s_waitcnt lgkmcnt(4)
    v_mfma_f32_16x16x32_f16 v[32:35], v[72:75], v[88:91], v[32:35]
    ds_read_b128 v[48:51], v12 offset:1280
    v_mfma_f32_16x16x32_f16 v[36:39], v[76:79], v[88:91], v[36:39]
    ds_read_b128 v[52:55], v13 offset:1280
    v_mfma_f32_16x16x32_f16 v[40:43], v[72:75], v[92:95], v[40:43]
    ds_read_b128 v[64:67], v14 offset:160
    v_mfma_f32_16x16x32_f16 v[44:47], v[76:79], v[92:95], v[44:47]
    ds_read_b128 v[68:71], v14 offset:672
    s_waitcnt lgkmcnt(4)
    v_mfma_f32_16x16x32_f16 v[32:35], v[96:99], v[112:115], v[32:35]
    ds_read_b128 v[72:75], v12 offset:1152
    v_mfma_f32_16x16x32_f16 v[36:39], v[100:103], v[112:115], v[36:39]
    ds_read_b128 v[76:79], v13 offset:1152
    v_mfma_f32_16x16x32_f16 v[40:43], v[96:99], v[116:119], v[40:43]
    ds_read_b128 v[88:91], v14 offset:96
    v_mfma_f32_16x16x32_f16 v[44:47], v[100:103], v[116:119], v[44:47]
    ds_read_b128 v[92:95], v14 offset:608
    s_waitcnt lgkmcnt(4)
    v_mfma_f32_16x16x32_f16 v[32:35], v[48:51], v[64:67], v[32:35]
    ds_read_b128 v[96:99], v12 offset:1024
    v_mfma_f32_16x16x32_f16 v[36:39], v[52:55], v[64:67], v[36:39]
    ds_read_b128 v[100:103], v13 offset:1024
    v_mfma_f32_16x16x32_f16 v[40:43], v[48:51], v[68:71], v[40:43]
    ds_read_b128 v[112:115], v14 offset:32
    v_mfma_f32_16x16x32_f16 v[44:47], v[52:55], v[68:71], v[44:47]
    ds_read_b128 v[116:119], v14 offset:544
    s_waitcnt lgkmcnt(4)
    v_mfma_f32_16x16x32_f16 v[32:35], v[72:75], v[88:91], v[32:35]
    ds_read_b128 v[48:51], v12 offset:896
    v_mfma_f32_16x16x32_f16 v[36:39], v[76:79], v[88:91], v[36:39]
    ds_read_b128 v[52:55], v13 offset:896
    v_mfma_f32_16x16x32_f16 v[40:43], v[72:75], v[92:95], v[40:43]
    ds_read_b128 v[68:71], v14 offset:480
    v_mfma_f32_16x16x32_f16 v[44:47], v[76:79], v[92:95], v[44:47]
    s_waitcnt lgkmcnt(3)
    v_mfma_f32_16x16x32_f16 v[32:35], v[96:99], v[112:115], v[32:35]
    ds_read_b128 v[72:75], v12 offset:768
    v_mfma_f32_16x16x32_f16 v[36:39], v[100:103], v[112:115], v[36:39]
    ds_read_b128 v[76:79], v13 offset:768
    v_mfma_f32_16x16x32_f16 v[40:43], v[96:99], v[116:119], v[40:43]
    ds_read_b128 v[92:95], v14 offset:416
    v_mfma_f32_16x16x32_f16 v[44:47], v[100:103], v[116:119], v[44:47]
    s_waitcnt lgkmcnt(3)
    v_mfma_f32_16x16x32_f16 v[40:43], v[48:51], v[68:71], v[40:43]
    ds_read_b128 v[96:99], v12 offset:640
    v_mfma_f32_16x16x32_f16 v[44:47], v[52:55], v[68:71], v[44:47]
    ds_read_b128 v[100:103], v13 offset:640
    ds_read_b128 v[116:119], v14 offset:352
    s_waitcnt lgkmcnt(3)
    v_mfma_f32_16x16x32_f16 v[40:43], v[72:75], v[92:95], v[40:43]
    ds_read_b128 v[48:51], v12 offset:512
    v_mfma_f32_16x16x32_f16 v[44:47], v[76:79], v[92:95], v[44:47]
    ds_read_b128 v[52:55], v13 offset:512
    ds_read_b128 v[68:71], v14 offset:288
    s_waitcnt lgkmcnt(3)
    v_mfma_f32_16x16x32_f16 v[40:43], v[96:99], v[116:119], v[40:43]
    ds_read_b128 v[72:75], v12 offset:384
    v_mfma_f32_16x16x32_f16 v[44:47], v[100:103], v[116:119], v[44:47]
    ds_read_b128 v[76:79], v13 offset:384
    ds_read_b128 v[92:95], v14 offset:224
    s_waitcnt lgkmcnt(3)
    v_mfma_f32_16x16x32_f16 v[40:43], v[48:51], v[68:71], v[40:43]
    ds_read_b128 v[96:99], v12 offset:256
    v_mfma_f32_16x16x32_f16 v[44:47], v[52:55], v[68:71], v[44:47]
    ds_read_b128 v[100:103], v13 offset:256
    ds_read_b128 v[116:119], v14 offset:160
    s_waitcnt lgkmcnt(3)
    v_mfma_f32_16x16x32_f16 v[40:43], v[72:75], v[92:95], v[40:43]
    ds_read_b128 v[48:51], v12 offset:128
    v_mfma_f32_16x16x32_f16 v[44:47], v[76:79], v[92:95], v[44:47]
    ds_read_b128 v[52:55], v13 offset:128
    ds_read_b128 v[68:71], v14 offset:96
    s_waitcnt lgkmcnt(3)
    v_mfma_f32_16x16x32_f16 v[40:43], v[96:99], v[116:119], v[40:43]
    ds_read_b128 v[72:75], v12 offset:0
    v_mfma_f32_16x16x32_f16 v[44:47], v[100:103], v[116:119], v[44:47]
    ds_read_b128 v[76:79], v13 offset:0
    ds_read_b128 v[92:95], v14 offset:32
    s_waitcnt lgkmcnt(3)
    v_mfma_f32_16x16x32_f16 v[40:43], v[48:51], v[68:71], v[40:43]
    v_mfma_f32_16x16x32_f16 v[44:47], v[52:55], v[68:71], v[44:47]
    s_waitcnt lgkmcnt(0)
    v_mfma_f32_16x16x32_f16 v[40:43], v[72:75], v[92:95], v[40:43]
    v_mfma_f32_16x16x32_f16 v[44:47], v[76:79], v[92:95], v[44:47]
    s_nop 7
    s_barrier
    s_lshl_b32 s70, s63, 12
    s_add_u32 s70, s70, s65
    s_add_u32 s70, s70, 4160
    v_add_u32 v8, s70, v2
    s_xor_b32 s71, s63, 1
    s_lshl_b32 s70, s71, 12
    s_add_u32 s70, s70, s65
    s_add_u32 s70, s70, 4160
    v_add_u32 v9, s70, v2
    s_cmp_eq_u32 s63, 0
    s_cbranch_scc1 FC_P0
    ds_write_b128 v8, v[16:19] offset:0
    ds_write_b128 v8, v[20:23] offset:1024
    ds_write_b128 v8, v[24:27] offset:2048
    ds_write_b128 v8, v[28:31] offset:3072
    v_pk_mov_b32 v[48:49], v[32:33], v[32:33] op_sel:[0,1]
    v_pk_mov_b32 v[50:51], v[34:35], v[34:35] op_sel:[0,1]
    v_pk_mov_b32 v[52:53], v[36:37], v[36:37] op_sel:[0,1]
    v_pk_mov_b32 v[54:55], v[38:39], v[38:39] op_sel:[0,1]
    v_pk_mov_b32 v[56:57], v[40:41], v[40:41] op_sel:[0,1]
    v_pk_mov_b32 v[58:59], v[42:43], v[42:43] op_sel:[0,1]
    v_pk_mov_b32 v[60:61], v[44:45], v[44:45] op_sel:[0,1]
    v_pk_mov_b32 v[62:63], v[46:47], v[46:47] op_sel:[0,1]
    s_branch FC_PJ
FC_P0:
    ds_write_b128 v8, v[32:35] offset:0
    ds_write_b128 v8, v[36:39] offset:1024
    ds_write_b128 v8, v[40:43] offset:2048
    ds_write_b128 v8, v[44:47] offset:3072
    v_pk_mov_b32 v[48:49], v[16:17], v[16:17] op_sel:[0,1]
    v_pk_mov_b32 v[50:51], v[18:19], v[18:19] op_sel:[0,1]
    v_pk_mov_b32 v[52:53], v[20:21], v[20:21] op_sel:[0,1]
    v_pk_mov_b32 v[54:55], v[22:23], v[22:23] op_sel:[0,1]
    v_pk_mov_b32 v[56:57], v[24:25], v[24:25] op_sel:[0,1]
    v_pk_mov_b32 v[58:59], v[26:27], v[26:27] op_sel:[0,1]
    v_pk_mov_b32 v[60:61], v[28:29], v[28:29] op_sel:[0,1]
    v_pk_mov_b32 v[62:63], v[30:31], v[30:31] op_sel:[0,1]
FC_PJ:
    s_waitcnt lgkmcnt(0)
    s_barrier
    ds_read_b128 v[64:67], v9 offset:0
    ds_read_b128 v[68:71], v9 offset:1024
    ds_read_b128 v[72:75], v9 offset:2048
    ds_read_b128 v[76:79], v9 offset:3072
    v_lshlrev_b32 v5, 6, v6
    v_lshl_add_u32 v5, v7, 4, v5
    s_lshl_b32 s70, s63, 11
    s_sub_u32 s70, s65, s70
    s_add_u32 s70, s70, 3056
    v_sub_u32 v8, s70, v5
    ds_read_b128 v[80:83], v8 offset:1024
    ds_read_b128 v[84:87], v8 offset:0
    s_lshl_b32 s70, s64, 12
    s_lshl_b32 s71, s63, 11
    s_add_u32 s70, s70, s71
    s_waitcnt lgkmcnt(0)
    v_pk_add_f32 v[48:49], v[48:49], v[64:65]
    v_pk_add_f32 v[50:51], v[50:51], v[66:67]
    v_pk_add_f32 v[52:53], v[52:53], v[68:69]
    v_pk_add_f32 v[54:55], v[54:55], v[70:71]
    v_ldexp_f32 v48, v48, v10
    v_ldexp_f32 v49, v49, v10
    v_ldexp_f32 v50, v50, v10
    v_ldexp_f32 v51, v51, v10
    v_ldexp_f32 v52, v52, v10
    v_ldexp_f32 v53, v53, v10
    v_ldexp_f32 v54, v54, v10
    v_ldexp_f32 v55, v55, v10
    v_cvt_pk_bf16_f32 v88, v48, v49
    v_cvt_pk_bf16_f32 v89, v50, v51
    v_cvt_pk_bf16_f32 v90, v52, v53
    v_cvt_pk_bf16_f32 v91, v54, v55
    v_lshlrev_b32 v48, 16, v88
    v_and_b32 v49, s72, v88
    v_lshlrev_b32 v50, 16, v89
    v_and_b32 v51, s72, v89
    v_lshlrev_b32 v52, 16, v90
    v_and_b32 v53, s72, v90
    v_lshlrev_b32 v54, 16, v91
    v_and_b32 v55, s72, v91
    v_cvt_f32_f16_sdwa v92, v83 dst_sel:DWORD dst_unused:UNUSED_PAD src0_sel:WORD_1
    v_cvt_f32_f16 v93, v83
    v_cvt_f32_f16_sdwa v94, v82 dst_sel:DWORD dst_unused:UNUSED_PAD src0_sel:WORD_1
    v_cvt_f32_f16 v95, v82
    v_cvt_f32_f16_sdwa v96, v81 dst_sel:DWORD dst_unused:UNUSED_PAD src0_sel:WORD_1
    v_cvt_f32_f16 v97, v81
    v_cvt_f32_f16_sdwa v98, v80 dst_sel:DWORD dst_unused:UNUSED_PAD src0_sel:WORD_1
    v_cvt_f32_f16 v99, v80
    v_mul_f32 v92, v92, v11
    v_mul_f32 v93, v93, v11
    v_mul_f32 v94, v94, v11
    v_mul_f32 v95, v95, v11
    v_mul_f32 v96, v96, v11
    v_mul_f32 v97, v97, v11
    v_mul_f32 v98, v98, v11
    v_mul_f32 v99, v99, v11
    v_cvt_pk_bf16_f32 v88, v92, v93
    v_cvt_pk_bf16_f32 v89, v94, v95
    v_cvt_pk_bf16_f32 v90, v96, v97
    v_cvt_pk_bf16_f32 v91, v98, v99
    v_lshlrev_b32 v92, 16, v88
    v_and_b32 v93, s72, v88
    v_lshlrev_b32 v94, 16, v89
    v_and_b32 v95, s72, v89
    v_lshlrev_b32 v96, 16, v90
    v_and_b32 v97, s72, v90
    v_lshlrev_b32 v98, 16, v91
    v_and_b32 v99, s72, v91
    v_pk_add_f32 v[48:49], v[48:49], v[92:93]
    v_pk_add_f32 v[50:51], v[50:51], v[94:95]
    v_pk_add_f32 v[52:53], v[52:53], v[96:97]
    v_pk_add_f32 v[54:55], v[54:55], v[98:99]
    v_cvt_pk_bf16_f32 v100, v48, v49
    v_cvt_pk_bf16_f32 v101, v50, v51
    v_cvt_pk_bf16_f32 v102, v52, v53
    v_cvt_pk_bf16_f32 v103, v54, v55
    buffer_store_dwordx4 v[100:103], v5, s[48:51], s70 offen offset:0 sc1
    v_pk_add_f32 v[56:57], v[56:57], v[72:73]
    v_pk_add_f32 v[58:59], v[58:59], v[74:75]
    v_pk_add_f32 v[60:61], v[60:61], v[76:77]
    v_pk_add_f32 v[62:63], v[62:63], v[78:79]
    v_ldexp_f32 v56, v56, v10
    v_ldexp_f32 v57, v57, v10
    v_ldexp_f32 v58, v58, v10
    v_ldexp_f32 v59, v59, v10
    v_ldexp_f32 v60, v60, v10
    v_ldexp_f32 v61, v61, v10
    v_ldexp_f32 v62, v62, v10
    v_ldexp_f32 v63, v63, v10
    v_cvt_pk_bf16_f32 v88, v56, v57
    v_cvt_pk_bf16_f32 v89, v58, v59
    v_cvt_pk_bf16_f32 v90, v60, v61
    v_cvt_pk_bf16_f32 v91, v62, v63
    v_lshlrev_b32 v56, 16, v88
    v_and_b32 v57, s72, v88
    v_lshlrev_b32 v58, 16, v89
    v_and_b32 v59, s72, v89
    v_lshlrev_b32 v60, 16, v90
    v_and_b32 v61, s72, v90
    v_lshlrev_b32 v62, 16, v91
    v_and_b32 v63, s72, v91
    v_cvt_f32_f16_sdwa v92, v87 dst_sel:DWORD dst_unused:UNUSED_PAD src0_sel:WORD_1
    v_cvt_f32_f16 v93, v87
    v_cvt_f32_f16_sdwa v94, v86 dst_sel:DWORD dst_unused:UNUSED_PAD src0_sel:WORD_1
    v_cvt_f32_f16 v95, v86
    v_cvt_f32_f16_sdwa v96, v85 dst_sel:DWORD dst_unused:UNUSED_PAD src0_sel:WORD_1
    v_cvt_f32_f16 v97, v85
    v_cvt_f32_f16_sdwa v98, v84 dst_sel:DWORD dst_unused:UNUSED_PAD src0_sel:WORD_1
    v_cvt_f32_f16 v99, v84
    v_mul_f32 v92, v92, v11
    v_mul_f32 v93, v93, v11
    v_mul_f32 v94, v94, v11
    v_mul_f32 v95, v95, v11
    v_mul_f32 v96, v96, v11
    v_mul_f32 v97, v97, v11
    v_mul_f32 v98, v98, v11
    v_mul_f32 v99, v99, v11
    v_cvt_pk_bf16_f32 v88, v92, v93
    v_cvt_pk_bf16_f32 v89, v94, v95
    v_cvt_pk_bf16_f32 v90, v96, v97
    v_cvt_pk_bf16_f32 v91, v98, v99
    v_lshlrev_b32 v92, 16, v88
    v_and_b32 v93, s72, v88
    v_lshlrev_b32 v94, 16, v89
    v_and_b32 v95, s72, v89
    v_lshlrev_b32 v96, 16, v90
    v_and_b32 v97, s72, v90
    v_lshlrev_b32 v98, 16, v91
    v_and_b32 v99, s72, v91
    v_pk_add_f32 v[56:57], v[56:57], v[92:93]
    v_pk_add_f32 v[58:59], v[58:59], v[94:95]
    v_pk_add_f32 v[60:61], v[60:61], v[96:97]
    v_pk_add_f32 v[62:63], v[62:63], v[98:99]
    v_cvt_pk_bf16_f32 v104, v56, v57
    v_cvt_pk_bf16_f32 v105, v58, v59
    v_cvt_pk_bf16_f32 v106, v60, v61
    v_cvt_pk_bf16_f32 v107, v62, v63
    buffer_store_dwordx4 v[104:107], v5, s[48:51], s70 offen offset:1024 sc1
    s_waitcnt vmcnt(0)
    s_barrier
    s_cmp_eq_u32 s60, 0
    s_cbranch_scc0 FC_SF
    s_lshl_b32 s70, s61, 2
    s_add_u32 s70, s70, 3072
    v_mov_b32 v36, 0
    v_mov_b32 v37, s34
    s_mov_b64 exec, 1
    buffer_store_dword v37, v36, s[52:55], s70 offen sc1
    s_mov_b64 exec, -1
    s_cmp_eq_u32 s61, 0
    s_cbranch_scc0 FC_SF
    v_lshlrev_b32 v34, 2, v1
    s_mov_b32 s70, 4096
    s_mov_b32 s76, 1048576
    s_mov_b64 s[74:75], -1
POLL_FC_9:
    buffer_load_dword v36, v34, s[52:55], s70 offen offset:0 sc1
    buffer_load_dword v37, v34, s[52:55], s70 offen offset:256 sc1
    buffer_load_dword v38, v34, s[52:55], s70 offen offset:512 sc1
    buffer_load_dword v39, v34, s[52:55], s70 offen offset:768 sc1
    s_waitcnt vmcnt(0)
    v_xor_b32 v37, s34, v37
    v_xor_b32 v38, s34, v38
    v_xor_b32 v39, s34, v39
    v_xor_b32 v36, s34, v36
    v_or_b32 v36, v36, v37
    v_or_b32 v36, v36, v38
    v_or_b32 v36, v36, v39
    v_cmp_ne_u32 vcc, 0, v36
    s_and_b64 vcc, vcc, s[74:75]
    s_cbranch_scc0 POLL_FC_9_D
    s_sleep 8
    s_sub_u32 s76, s76, 1
    s_cmp_lg_u32 s76, 0
    s_cbranch_scc1 POLL_FC_9
POLL_FC_9_D:
    s_add_u32 s35, s35, 1
    v_mov_b32 v34, 0
    v_mov_b32 v35, s35
    s_mov_b32 s70, 5120
    s_mov_b64 exec, 1
    buffer_store_dword v35, v34, s[52:55], s70 offen sc1
    s_mov_b64 exec, -1
FC_SF:
    s_endpgm
F_END:
    s_endpgm
.section .rodata,"a"
.p2align 6
.amdhsa_kernel recurrent_scan__ssm_conv_s4d__dense_activation_gelu__prompt_kernel
  .amdhsa_next_free_vgpr 256
  .amdhsa_next_free_sgpr 102
  .amdhsa_accum_offset 256
  .amdhsa_group_segment_fixed_size 0
  .amdhsa_kernarg_size 120
  .amdhsa_user_sgpr_count 2
  .amdhsa_user_sgpr_kernarg_segment_ptr 1
  .amdhsa_system_sgpr_workgroup_id_x 1
.end_amdhsa_kernel
```
